```python
import torch

def _softmax(x, axis=-1):
    return torch.softmax(x, dim=axis)
def _gelu(x):
    return torch.nn.functional.gelu(x, approximate="tanh")
def _silu(x):
    return torch.nn.functional.silu(x)
def _sigmoid(x):
    return torch.sigmoid(x)
def _layernorm(x, axis=-1, eps=1e-5):
    m = x.mean(dim=axis, keepdim=True)
    v = x.var(dim=axis, keepdim=True, unbiased=False)
    return (x - m) / torch.sqrt(v + eps)
def _scatter_add(tgt, idx, src, axis=0):
    return tgt.clone().index_add_(axis, idx, src)
def _segment_sum(src, seg, n):
    out = torch.zeros((n,) + src.shape[1:], dtype=src.dtype)
    return out.index_add_(0, seg, src)
def _pad(x, pw):
    flat = tuple(v for pair in reversed(pw) for v in pair)
    return torch.nn.functional.pad(x, flat)

kernel_name = 'recurrent_scan__sliding_block_cached__geglu_ffn__decode'

def setup_inputs():

    _w = (lambda a: (lambda t: t.to(torch.bfloat16) if t.is_floating_point() else t)(torch.as_tensor(a)))
    def _A_setup():
        B, Sq, D = 1, 1, 512
        Hq, Hkv, Sk, Dh = 32, 32, 32768, 128
        assert Hq % Hkv == 0, (Hq, Hkv)
        return {
            "x": _w((lambda *s: torch.randn(*s, dtype=torch.bfloat16) * 0.05)(B, Sq, D)),
            "k_cache": _w((lambda *s: torch.randn(*s, dtype=torch.bfloat16) * 1.6)(B, Hkv, Sk, Dh)),
            "v_cache": _w((lambda *s: torch.randn(*s, dtype=torch.bfloat16) * 0.2)(B, Hkv, Sk, Dh)),
            "wq": _w((lambda *s: torch.randn(*s, dtype=torch.bfloat16) * 1.6)(D, Hq * Dh) * (D ** -0.5)),
            "wo": _w((lambda *s: torch.randn(*s, dtype=torch.bfloat16) * 0.2)(Hq * Dh, D) * ((Hq * Dh) ** -0.5)),
        }
    _A_in = _A_setup()

    def _B_setup():
        B, S, D, F = 1, 1, 512, 1376
        return {
            "x": _w((lambda *s: torch.randn(*s, dtype=torch.bfloat16) * 0.05)(B, S, D)),
            "w_gate": _w((lambda *s: torch.randn(*s, dtype=torch.bfloat16) * 0.1)(D, F)),
            "w_up": _w((lambda *s: torch.randn(*s, dtype=torch.bfloat16) * 0.1)(D, F)),
            "w_down": _w((lambda *s: torch.randn(*s, dtype=torch.bfloat16) * 0.1)(F, D)),
        }
    _B_in = _B_setup()

    return {
        "A_x": _A_in["x"],
        "A_k_cache": _A_in["k_cache"],
        "A_v_cache": _A_in["v_cache"],
        "A_wq": _A_in["wq"],
        "A_wo": _A_in["wo"],
        "B_x": _B_in["x"],
        "B_w_gate": _B_in["w_gate"],
        "B_w_up": _B_in["w_up"],
        "B_w_down": _B_in["w_down"],
    }

def reference(A_x, A_k_cache, A_v_cache, A_wq, A_wo, B_x, B_w_gate, B_w_up, B_w_down):
    def _A_ref(x, k_cache, v_cache, wq, wo):
        B, Sq, D = x.shape
        Hq, Dh = 32, 128
        Hkv, Sk = k_cache.shape[1], k_cache.shape[2]
        W = min(4096, max(256, Sk // 4))
        rep = Hq // Hkv
        q = (lambda x, *d: x.permute(*d))((x @ wq).reshape(B, Sq, Hq, Dh), 0, 2, 1, 3)
        k = (lambda x, n, axis: torch.repeat_interleave(x, n, dim=axis))(k_cache[:, :, Sk - W:, :], rep, axis=1)
        v = (lambda x, n, axis: torch.repeat_interleave(x, n, dim=axis))(v_cache[:, :, Sk - W:, :], rep, axis=1)
        scores = torch.einsum("bhqd,bhkd->bhqk", q, k) * (Dh ** -0.5)
        p = _softmax(scores, axis=-1)
        o = torch.einsum("bhqk,bhkd->bhqd", p, v)
        return (lambda x, *d: x.permute(*d))(o, 0, 2, 1, 3).reshape(B, Sq, Hq * Dh) @ wo

    def _B_ref(x, w_gate, w_up, w_down):
        return (_gelu(x @ w_gate) * (x @ w_up)) @ w_down

    x = A_x
    xn = _layernorm(x, axis=-1)
    s = _A_ref(xn, A_k_cache, A_v_cache, A_wq, A_wo)
    g = _silu(_B_ref(xn, B_w_gate, B_w_up, B_w_down))
    return x + s * g
```

```asm
; @launch grid=(256,1,1) block=(512,1,1) lds=6656
.amdgcn_target "amdgcn-amd-amdhsa--gfx950"
.text
.globl recurrent_scan__sliding_block_cached__geglu_ffn__decode_kernel
.p2align 8
.type recurrent_scan__sliding_block_cached__geglu_ffn__decode_kernel,@function
recurrent_scan__sliding_block_cached__geglu_ffn__decode_kernel:
  s_load_dwordx16 s[32:47], s[0:1], 0
  s_load_dwordx8 s[48:55], s[0:1], 64
  s_getpc_b64 s[30:31]
L_pc0:
  v_lshlrev_b32 v9, 7, v0
  v_min_u32 v9, L_code_end-L_pc0-4, v9
  global_load_dword v63, v9, s[30:31]
  v_lshrrev_b32 v1, 6, v0
  v_and_b32 v0, 63, v0
  s_lshr_b32 s60, s2, 3
  v_readfirstlane_b32 s3, v1
  s_cmp_ge_u32 s60, 32
  s_cbranch_scc1 L_end
  s_and_b32 s59, s2, 7
  s_lshr_b32 s29, s60, 3
  s_lshl2_add_u32 s24, s59, s29
  s_and_b32 s25, s60, 7
  s_mov_b32 s7, 0x20000
  s_cmp_lt_u32 s3, 4
  s_cbranch_scc1 L_stream
  v_lshrrev_b32 v28, 4, v0
  v_and_b32 v29, 15, v0
  v_lshlrev_b32 v30, 4, v29
  s_cmp_lt_u32 s3, 6
  s_cbranch_scc1 L_tile0
  s_cmp_eq_u32 s3, 7
  s_cbranch_scc1 L_other
  s_branch L_other1
L_tile0:
  s_lshr_b32 s58, s60, 4
  s_lshl1_add_u32 s58, s59, s58
  s_mulk_i32 s58, 176
  s_lshl_b32 s29, s24, 8
  s_movk_i32 s56, 2752
  s_cmp_eq_u32 s3, 4
  s_cselect_b32 s29, s29, s58
  s_cselect_b32 s56, 0x2000, s56
  s_cselect_b32 s58, -1, 0x07ff07ff
  s_lshl_b32 s6, s56, 9
  s_lshl_b32 s30, s56, 4
  v_lshl_add_u32 v2, s25, 2, v28
  v_mad_u32_u24 v2, s30, v2, v30
  v_lshlrev_b32 v1, 4, v0
  s_waitcnt lgkmcnt(0)
  s_bitcmp1_b32 s60, 3
  s_cselect_b64 s[4:5], s[46:47], s[44:45]
  s_cmp_eq_u32 s3, 4
  s_cselect_b64 s[4:5], s[38:39], s[4:5]
  global_load_dwordx4 v[8:11], v1, s[32:33]
  s_mov_b32 exec_lo, s58
  s_mov_b32 exec_hi, s58
  buffer_load_dwordx4 v[64:67], v2, s[4:7], s29 offen nt
  s_add_u32 s29, s29, s56
  buffer_load_dwordx4 v[68:71], v2, s[4:7], s29 offen nt
  s_add_u32 s29, s29, s56
  buffer_load_dwordx4 v[72:75], v2, s[4:7], s29 offen nt
  s_add_u32 s29, s29, s56
  buffer_load_dwordx4 v[76:79], v2, s[4:7], s29 offen nt
  s_add_u32 s29, s29, s56
  buffer_load_dwordx4 v[80:83], v2, s[4:7], s29 offen nt
  s_add_u32 s29, s29, s56
  buffer_load_dwordx4 v[84:87], v2, s[4:7], s29 offen nt
  s_add_u32 s29, s29, s56
  buffer_load_dwordx4 v[88:91], v2, s[4:7], s29 offen nt
  s_add_u32 s29, s29, s56
  buffer_load_dwordx4 v[92:95], v2, s[4:7], s29 offen nt
  s_add_u32 s29, s29, s56
  buffer_load_dwordx4 v[96:99], v2, s[4:7], s29 offen nt
  s_add_u32 s29, s29, s56
  buffer_load_dwordx4 v[100:103], v2, s[4:7], s29 offen nt
  s_add_u32 s29, s29, s56
  buffer_load_dwordx4 v[104:107], v2, s[4:7], s29 offen nt
  s_add_u32 s29, s29, s56
  buffer_load_dwordx4 v[108:111], v2, s[4:7], s29 offen nt
  s_add_u32 s29, s29, s56
  buffer_load_dwordx4 v[112:115], v2, s[4:7], s29 offen nt
  s_add_u32 s29, s29, s56
  buffer_load_dwordx4 v[116:119], v2, s[4:7], s29 offen nt
  s_add_u32 s29, s29, s56
  buffer_load_dwordx4 v[120:123], v2, s[4:7], s29 offen nt
  s_add_u32 s29, s29, s56
  buffer_load_dwordx4 v[124:127], v2, s[4:7], s29 offen nt
  s_branch L_tile1
  .fill (512-(.-recurrent_scan__sliding_block_cached__geglu_ffn__decode_kernel))/4, 4, 0xbf800000
L_stream:
  s_branch L_stream1
L_tile1:
  s_mov_b64 exec, -1
  s_barrier
  s_branch L_tile
L_other:
  v_mov_b32 v60, 0
  v_lshlrev_b32 v61, 2, v29
  ds_write_b32 v61, v60 offset:384
  s_waitcnt lgkmcnt(0)
L_other1:
  s_barrier
  s_branch L_other2
L_stream1:
  s_mov_b32 s6, 0x10000000
  s_mov_b32 s11, 0x20000
  s_mov_b32 s10, 0x10000000
  s_lshl_b32 s29, s24, 23
  s_lshl_b32 s30, s25, 17
  s_add_u32 s29, s29, s30
  s_lshl_b32 s30, s3, 15
  s_add_u32 s29, s29, s30
  s_add_u32 s29, s29, 0x700000
  s_mul_i32 s30, s3, 2
  s_add_u32 s30, s30, s2
  s_lshl_b32 s30, s30, 12
  s_movk_i32 s31, 0x7000
  s_and_b32 s16, s30, s31
  s_addk_i32 s30, 0x1000
  s_and_b32 s17, s30, s31
  s_addk_i32 s30, 0x1000
  s_and_b32 s18, s30, s31
  s_addk_i32 s30, 0x1000
  s_and_b32 s19, s30, s31
  s_addk_i32 s30, 0x1000
  s_and_b32 s20, s30, s31
  s_addk_i32 s30, 0x1000
  s_and_b32 s21, s30, s31
  s_addk_i32 s30, 0x1000
  s_and_b32 s22, s30, s31
  s_addk_i32 s30, 0x1000
  s_and_b32 s23, s30, s31
  v_and_b32 v1, 3, v0
  v_lshlrev_b32 v1, 4, v1
  v_lshrrev_b32 v2, 4, v0
  v_lshl_or_b32 v59, v2, 6, v1
  v_bfe_u32 v2, v0, 2, 2
  v_lshl_or_b32 v1, v2, 8, v59
  v_add_u32 v1, s29, v1
  v_lshl_add_u32 v2, v0, 4, s29
  s_waitcnt lgkmcnt(0)
  s_mov_b64 s[4:5], s[34:35]
  s_mov_b64 s[8:9], s[36:37]
  s_barrier
  buffer_load_dwordx4 v[128:131], v1, s[4:7], s16 offen offset:0 nt
  buffer_load_dwordx4 v[132:135], v1, s[4:7], s17 offen offset:1024 nt
  buffer_load_dwordx4 v[136:139], v1, s[4:7], s18 offen offset:2048 nt
  buffer_load_dwordx4 v[140:143], v1, s[4:7], s19 offen offset:3072 nt
  buffer_load_dwordx4 v[144:147], v1, s[4:7], s20 offen offset:0 nt
  buffer_load_dwordx4 v[148:151], v1, s[4:7], s21 offen offset:1024 nt
  buffer_load_dwordx4 v[152:155], v1, s[4:7], s22 offen offset:2048 nt
  buffer_load_dwordx4 v[156:159], v1, s[4:7], s23 offen offset:3072 nt
  s_mov_b64 s[12:13], s[54:55]
  s_mov_b32 s14, 2097152
  s_mov_b32 s15, 0x20000
  s_load_dword s26, s[54:55], 0
  v_and_b32 v51, 1, v0
  v_lshlrev_b32 v51, 3, v51
  v_lshrrev_b32 v50, 4, v0
  v_lshl_or_b32 v51, v50, 1, v51
  s_lshl3_add_u32 s58, s59, s25
  s_lshl_b32 s29, s58, 4
  v_add_u32 v51, s29, v51
  s_lshr_b32 s38, s60, 3
  s_xor_b32 s38, s38, 3
  s_or_b32 s38, s38, s3
  s_cbranch_scc1 L_no_x
  global_load_ushort v50, v51, s[32:33]
  global_load_ushort v49, v51, s[50:51]
L_no_x:
  v_bfe_u32 v60, v0, 1, 2
  v_and_b32 v61, 1, v0
  v_lshlrev_b32 v61, 4, v61
  v_mov_b32 v62, 0xffff
  v_lshlrev_b32 v62, v61, v62
  v_cmp_eq_u32 vcc, 0, v60
  s_nop 1
  v_cndmask_b32 v3, 0, v62, vcc
  v_cmp_eq_u32 vcc, 1, v60
  s_nop 1
  v_cndmask_b32 v4, 0, v62, vcc
  v_cmp_eq_u32 vcc, 2, v60
  s_nop 1
  v_cndmask_b32 v5, 0, v62, vcc
  v_cmp_eq_u32 vcc, 3, v60
  s_nop 1
  v_cndmask_b32 v6, 0, v62, vcc
  s_mov_b32 s40, 0xf000f
  s_mov_b32 s41, 0xf000f
  s_mov_b32 s42, 0xf000f0
  s_mov_b32 s43, 0xf000f0
  s_mov_b32 s44, 0xf000f00
  s_mov_b32 s45, 0xf000f00
  s_mov_b32 s46, 0xf000f000
  s_mov_b32 s47, 0xf000f000
  s_mov_b32 s28, 0xfffff000
  s_mov_b32 s33, 0x3fb8aa3b
  s_lshl3_add_u32 s34, s24, s25
  s_lshl2_add_u32 s34, s34, s3
  s_lshr_b32 s37, s34, 2
  s_mul_i32 s37, s37, 640
  s_add_u32 s37, s37, 524288
  v_and_b32 v58, 15, v0
  v_lshlrev_b32 v58, 5, v58
  v_bfe_u32 v57, v0, 4, 1
  v_lshl_or_b32 v58, v57, 4, v58
  s_lshl_b32 s35, s3, 9
  v_add_u32 v56, s35, v58
  s_lshl_b32 s35, s3, 3
  v_mov_b32 v52, s35
  v_mov_b32 v57, 0
  v_mov_b32 v53, 1
  s_waitcnt vmcnt(7)
  buffer_load_dwordx4 v[160:163], v1, s[4:7], s16 offen offset:1024 nt
  s_waitcnt vmcnt(7)
  buffer_load_dwordx4 v[164:167], v1, s[4:7], s17 offen offset:2048 nt
  s_waitcnt vmcnt(7)
  buffer_load_dwordx4 v[168:171], v1, s[4:7], s18 offen offset:3072 nt
  s_waitcnt vmcnt(7)
  buffer_load_dwordx4 v[172:175], v1, s[4:7], s19 offen offset:0 nt
  s_waitcnt vmcnt(7)
  buffer_load_dwordx4 v[176:179], v1, s[4:7], s20 offen offset:1024 nt
  s_waitcnt vmcnt(7)
  buffer_load_dwordx4 v[180:183], v1, s[4:7], s21 offen offset:2048 nt
  s_waitcnt vmcnt(7)
  buffer_load_dwordx4 v[184:187], v1, s[4:7], s22 offen offset:3072 nt
  s_waitcnt vmcnt(7)
  buffer_load_dwordx4 v[188:191], v1, s[4:7], s23 offen offset:0 nt
  s_waitcnt vmcnt(7)
  buffer_load_dwordx4 v[192:195], v1, s[4:7], s16 offen offset:2048 nt
  s_waitcnt vmcnt(7)
  buffer_load_dwordx4 v[196:199], v1, s[4:7], s17 offen offset:3072 nt
  s_waitcnt vmcnt(7)
  buffer_load_dwordx4 v[200:203], v1, s[4:7], s18 offen offset:0 nt
  s_waitcnt vmcnt(7)
  buffer_load_dwordx4 v[204:207], v1, s[4:7], s19 offen offset:1024 nt
  s_waitcnt vmcnt(7)
  buffer_load_dwordx4 v[208:211], v1, s[4:7], s20 offen offset:2048 nt
  s_waitcnt vmcnt(7)
  buffer_load_dwordx4 v[212:215], v1, s[4:7], s21 offen offset:3072 nt
  s_waitcnt vmcnt(7)
  buffer_load_dwordx4 v[216:219], v1, s[4:7], s22 offen offset:0 nt
  s_waitcnt vmcnt(7)
  buffer_load_dwordx4 v[220:223], v1, s[4:7], s23 offen offset:1024 nt
  s_waitcnt vmcnt(7)
  buffer_load_dwordx4 v[224:227], v1, s[4:7], s16 offen offset:3072 nt
  s_mov_b64 exec, 1
  ds_add_u32 v57, v53 offset:400
  s_mov_b64 exec, -1
  s_waitcnt vmcnt(7)
  buffer_load_dwordx4 v[228:231], v1, s[4:7], s17 offen offset:0 nt
  s_waitcnt vmcnt(7)
  buffer_load_dwordx4 v[232:235], v1, s[4:7], s18 offen offset:1024 nt
  s_mov_b64 exec, 1
  ds_add_u32 v57, v53 offset:396
  s_mov_b64 exec, -1
  s_waitcnt vmcnt(7)
  buffer_load_dwordx4 v[236:239], v1, s[4:7], s19 offen offset:2048 nt
  s_waitcnt vmcnt(7)
  buffer_load_dwordx4 v[240:243], v1, s[4:7], s20 offen offset:3072 nt
  s_waitcnt vmcnt(7)
  buffer_load_dwordx4 v[244:247], v1, s[4:7], s21 offen offset:0 nt
  s_waitcnt vmcnt(7)
  buffer_load_dwordx4 v[248:251], v1, s[4:7], s22 offen offset:1024 nt
  s_waitcnt vmcnt(7)
  buffer_load_dwordx4 v[252:255], v1, s[4:7], s23 offen offset:2048 nt
  s_waitcnt vmcnt(7)
  buffer_load_dwordx4 v[64:67], v2, s[8:11], s16 offen offset:0 nt
  s_waitcnt vmcnt(7)
  buffer_load_dwordx4 v[68:71], v2, s[8:11], s17 offen offset:1024 nt
  s_waitcnt vmcnt(7)
  buffer_load_dwordx4 v[72:75], v2, s[8:11], s18 offen offset:2048 nt
  s_waitcnt vmcnt(7)
  buffer_load_dwordx4 v[76:79], v2, s[8:11], s19 offen offset:3072 nt
  s_waitcnt vmcnt(7)
  buffer_load_dwordx4 v[80:83], v2, s[8:11], s20 offen offset:0 nt
  s_waitcnt vmcnt(7)
  buffer_load_dwordx4 v[84:87], v2, s[8:11], s21 offen offset:1024 nt
  s_waitcnt vmcnt(7)
  buffer_load_dwordx4 v[88:91], v2, s[8:11], s22 offen offset:2048 nt
  s_waitcnt vmcnt(7)
  buffer_load_dwordx4 v[92:95], v2, s[8:11], s23 offen offset:3072 nt
  s_waitcnt vmcnt(7)
  buffer_load_dwordx4 v[96:99], v2, s[8:11], s16 offen offset:1024 nt
  s_waitcnt vmcnt(7)
  buffer_load_dwordx4 v[100:103], v2, s[8:11], s17 offen offset:2048 nt
  s_waitcnt vmcnt(7)
  buffer_load_dwordx4 v[104:107], v2, s[8:11], s18 offen offset:3072 nt
  s_waitcnt vmcnt(7)
  buffer_load_dwordx4 v[108:111], v2, s[8:11], s19 offen offset:0 nt
  s_waitcnt vmcnt(7)
  buffer_load_dwordx4 v[112:115], v2, s[8:11], s20 offen offset:1024 nt
  s_mov_b64 exec, 1
  ds_add_u32 v57, v53 offset:436
  s_mov_b64 exec, -1
  s_waitcnt vmcnt(7)
  buffer_load_dwordx4 v[116:119], v2, s[8:11], s21 offen offset:2048 nt
  s_waitcnt vmcnt(7)
  buffer_load_dwordx4 v[120:123], v2, s[8:11], s22 offen offset:3072 nt
  s_waitcnt vmcnt(7)
  buffer_load_dwordx4 v[124:127], v2, s[8:11], s23 offen offset:0 nt
  s_waitcnt lgkmcnt(0)
  s_add_u32 s27, s26, 1
  s_and_b32 s27, s27, 4095
  v_mov_b32 v7, s27
  s_mov_b32 s32, 0
L_wait_q:
  ds_read_b32 v55, v57 offset:384
  ds_read_b128 v[60:63], v59 offset:0
  s_waitcnt lgkmcnt(0)
  v_readfirstlane_b32 s39, v55
  s_cmp_lg_u32 s39, 0
  s_cbranch_scc1 L_have_q
  s_add_u32 s32, s32, 1
  s_cmp_lt_u32 s32, 6400000
  s_cbranch_scc1 L_wait_q
L_have_q:
  v_cndmask_b32_e64 v20, 0, v60, s[40:41]
  v_cndmask_b32_e64 v21, 0, v61, s[40:41]
  v_cndmask_b32_e64 v22, 0, v62, s[40:41]
  v_cndmask_b32_e64 v23, 0, v63, s[40:41]
  v_cndmask_b32_e64 v24, 0, v60, s[42:43]
  v_cndmask_b32_e64 v25, 0, v61, s[42:43]
  v_cndmask_b32_e64 v26, 0, v62, s[42:43]
  v_cndmask_b32_e64 v27, 0, v63, s[42:43]
  v_cndmask_b32_e64 v28, 0, v60, s[44:45]
  v_cndmask_b32_e64 v29, 0, v61, s[44:45]
  v_cndmask_b32_e64 v30, 0, v62, s[44:45]
  v_cndmask_b32_e64 v31, 0, v63, s[44:45]
  v_cndmask_b32_e64 v32, 0, v60, s[46:47]
  v_cndmask_b32_e64 v33, 0, v61, s[46:47]
  v_cndmask_b32_e64 v34, 0, v62, s[46:47]
  v_cndmask_b32_e64 v35, 0, v63, s[46:47]
  s_nop 1
  v_mfma_f32_16x16x32_bf16 v[8:11], v[128:131], v[20:23], 0
  v_mfma_f32_16x16x32_bf16 v[8:11], v[132:135], v[24:27], v[8:11]
  v_mfma_f32_16x16x32_bf16 v[8:11], v[136:139], v[28:31], v[8:11]
  v_mfma_f32_16x16x32_bf16 v[8:11], v[140:143], v[32:35], v[8:11]
  v_mfma_f32_16x16x32_bf16 v[12:15], v[144:147], v[20:23], 0
  v_mfma_f32_16x16x32_bf16 v[12:15], v[148:151], v[24:27], v[12:15]
  v_mfma_f32_16x16x32_bf16 v[12:15], v[152:155], v[28:31], v[12:15]
  v_mfma_f32_16x16x32_bf16 v[12:15], v[156:159], v[32:35], v[12:15]
  v_mfma_f32_16x16x32_bf16 v[16:19], v[160:163], v[20:23], 0
  v_mfma_f32_16x16x32_bf16 v[16:19], v[164:167], v[24:27], v[16:19]
  v_mfma_f32_16x16x32_bf16 v[16:19], v[168:171], v[28:31], v[16:19]
  v_mfma_f32_16x16x32_bf16 v[16:19], v[172:175], v[32:35], v[16:19]
  v_mfma_f32_16x16x32_bf16 v[44:47], v[176:179], v[20:23], 0
  v_mfma_f32_16x16x32_bf16 v[44:47], v[180:183], v[24:27], v[44:47]
  v_mfma_f32_16x16x32_bf16 v[44:47], v[184:187], v[28:31], v[44:47]
  v_mfma_f32_16x16x32_bf16 v[44:47], v[188:191], v[32:35], v[44:47]
  s_waitcnt vmcnt(7)
  buffer_load_dwordx4 v[128:131], v2, s[8:11], s16 offen offset:2048 nt
  s_waitcnt vmcnt(7)
  buffer_load_dwordx4 v[132:135], v2, s[8:11], s17 offen offset:3072 nt
  s_nop 7
  v_mov_b32_dpp v36, v8 quad_perm:[0,0,0,0] row_mask:0xf bank_mask:0xf
  v_mov_b32_dpp v37, v12 quad_perm:[0,0,0,0] row_mask:0xf bank_mask:0xf
  v_mov_b32_dpp v38, v16 quad_perm:[0,0,0,0] row_mask:0xf bank_mask:0xf
  v_mov_b32_dpp v39, v44 quad_perm:[0,0,0,0] row_mask:0xf bank_mask:0xf
  v_add_f32_dpp v36, v9, v36 quad_perm:[1,1,1,1] row_mask:0xf bank_mask:0xf
  v_add_f32_dpp v37, v13, v37 quad_perm:[1,1,1,1] row_mask:0xf bank_mask:0xf
  v_add_f32_dpp v38, v17, v38 quad_perm:[1,1,1,1] row_mask:0xf bank_mask:0xf
  v_add_f32_dpp v39, v45, v39 quad_perm:[1,1,1,1] row_mask:0xf bank_mask:0xf
  v_add_f32_dpp v36, v10, v36 quad_perm:[2,2,2,2] row_mask:0xf bank_mask:0xf
  v_add_f32_dpp v37, v14, v37 quad_perm:[2,2,2,2] row_mask:0xf bank_mask:0xf
  v_add_f32_dpp v38, v18, v38 quad_perm:[2,2,2,2] row_mask:0xf bank_mask:0xf
  v_add_f32_dpp v39, v46, v39 quad_perm:[2,2,2,2] row_mask:0xf bank_mask:0xf
  v_add_f32_dpp v36, v11, v36 quad_perm:[3,3,3,3] row_mask:0xf bank_mask:0xf
  v_add_f32_dpp v37, v15, v37 quad_perm:[3,3,3,3] row_mask:0xf bank_mask:0xf
  v_add_f32_dpp v38, v19, v38 quad_perm:[3,3,3,3] row_mask:0xf bank_mask:0xf
  v_add_f32_dpp v39, v47, v39 quad_perm:[3,3,3,3] row_mask:0xf bank_mask:0xf
  v_mfma_f32_16x16x32_bf16 v[8:11], v[192:195], v[20:23], 0
  v_mfma_f32_16x16x32_bf16 v[8:11], v[196:199], v[24:27], v[8:11]
  v_mfma_f32_16x16x32_bf16 v[8:11], v[200:203], v[28:31], v[8:11]
  v_mfma_f32_16x16x32_bf16 v[8:11], v[204:207], v[32:35], v[8:11]
  v_mfma_f32_16x16x32_bf16 v[12:15], v[208:211], v[20:23], 0
  v_mfma_f32_16x16x32_bf16 v[12:15], v[212:215], v[24:27], v[12:15]
  v_mfma_f32_16x16x32_bf16 v[12:15], v[216:219], v[28:31], v[12:15]
  v_mfma_f32_16x16x32_bf16 v[12:15], v[220:223], v[32:35], v[12:15]
  v_mfma_f32_16x16x32_bf16 v[16:19], v[224:227], v[20:23], 0
  v_mfma_f32_16x16x32_bf16 v[16:19], v[228:231], v[24:27], v[16:19]
  v_mfma_f32_16x16x32_bf16 v[16:19], v[232:235], v[28:31], v[16:19]
  v_mfma_f32_16x16x32_bf16 v[16:19], v[236:239], v[32:35], v[16:19]
  v_mfma_f32_16x16x32_bf16 v[44:47], v[240:243], v[20:23], 0
  v_mfma_f32_16x16x32_bf16 v[44:47], v[244:247], v[24:27], v[44:47]
  v_mfma_f32_16x16x32_bf16 v[44:47], v[248:251], v[28:31], v[44:47]
  v_mfma_f32_16x16x32_bf16 v[44:47], v[252:255], v[32:35], v[44:47]
  s_waitcnt vmcnt(7)
  buffer_load_dwordx4 v[136:139], v2, s[8:11], s18 offen offset:0 nt
  s_waitcnt vmcnt(7)
  buffer_load_dwordx4 v[140:143], v2, s[8:11], s19 offen offset:1024 nt
  s_nop 7
  v_mov_b32_dpp v40, v8 quad_perm:[0,0,0,0] row_mask:0xf bank_mask:0xf
  v_mov_b32_dpp v41, v12 quad_perm:[0,0,0,0] row_mask:0xf bank_mask:0xf
  v_mov_b32_dpp v42, v16 quad_perm:[0,0,0,0] row_mask:0xf bank_mask:0xf
  v_mov_b32_dpp v43, v44 quad_perm:[0,0,0,0] row_mask:0xf bank_mask:0xf
  v_add_f32_dpp v40, v9, v40 quad_perm:[1,1,1,1] row_mask:0xf bank_mask:0xf
  v_add_f32_dpp v41, v13, v41 quad_perm:[1,1,1,1] row_mask:0xf bank_mask:0xf
  v_add_f32_dpp v42, v17, v42 quad_perm:[1,1,1,1] row_mask:0xf bank_mask:0xf
  v_add_f32_dpp v43, v45, v43 quad_perm:[1,1,1,1] row_mask:0xf bank_mask:0xf
  v_add_f32_dpp v40, v10, v40 quad_perm:[2,2,2,2] row_mask:0xf bank_mask:0xf
  v_add_f32_dpp v41, v14, v41 quad_perm:[2,2,2,2] row_mask:0xf bank_mask:0xf
  v_add_f32_dpp v42, v18, v42 quad_perm:[2,2,2,2] row_mask:0xf bank_mask:0xf
  v_add_f32_dpp v43, v46, v43 quad_perm:[2,2,2,2] row_mask:0xf bank_mask:0xf
  v_add_f32_dpp v40, v11, v40 quad_perm:[3,3,3,3] row_mask:0xf bank_mask:0xf
  v_add_f32_dpp v41, v15, v41 quad_perm:[3,3,3,3] row_mask:0xf bank_mask:0xf
  v_add_f32_dpp v42, v19, v42 quad_perm:[3,3,3,3] row_mask:0xf bank_mask:0xf
  v_add_f32_dpp v43, v47, v43 quad_perm:[3,3,3,3] row_mask:0xf bank_mask:0xf
  v_cvt_pk_bf16_f32 v60, v36, v37
  v_lshlrev_b32 v36, 16, v60
  v_and_b32 v37, 0xffff0000, v60
  v_mul_f32 v36, 0x3db504f3, v36
  v_mul_f32 v37, 0x3db504f3, v37
  v_cvt_pk_bf16_f32 v60, v36, v37
  v_lshlrev_b32 v36, 16, v60
  v_and_b32 v37, 0xffff0000, v60
  v_cvt_pk_bf16_f32 v60, v38, v39
  v_lshlrev_b32 v38, 16, v60
  v_and_b32 v39, 0xffff0000, v60
  v_mul_f32 v38, 0x3db504f3, v38
  v_mul_f32 v39, 0x3db504f3, v39
  v_cvt_pk_bf16_f32 v60, v38, v39
  v_lshlrev_b32 v38, 16, v60
  v_and_b32 v39, 0xffff0000, v60
  v_cvt_pk_bf16_f32 v60, v40, v41
  v_lshlrev_b32 v40, 16, v60
  v_and_b32 v41, 0xffff0000, v60
  v_mul_f32 v40, 0x3db504f3, v40
  v_mul_f32 v41, 0x3db504f3, v41
  v_cvt_pk_bf16_f32 v60, v40, v41
  v_lshlrev_b32 v40, 16, v60
  v_and_b32 v41, 0xffff0000, v60
  v_cvt_pk_bf16_f32 v60, v42, v43
  v_lshlrev_b32 v42, 16, v60
  v_and_b32 v43, 0xffff0000, v60
  v_mul_f32 v42, 0x3db504f3, v42
  v_mul_f32 v43, 0x3db504f3, v43
  v_cvt_pk_bf16_f32 v60, v42, v43
  v_lshlrev_b32 v42, 16, v60
  v_and_b32 v43, 0xffff0000, v60
  v_max3_f32 v60, v36, v37, v38
  v_max3_f32 v61, v39, v40, v41
  v_max3_f32 v60, v60, v42, v43
  v_max_f32 v60, v60, v61
  s_nop 1
  v_max_f32_dpp v60, v60, v60 row_ror:4 row_mask:0xf bank_mask:0xf
  s_nop 1
  v_max_f32_dpp v60, v60, v60 row_ror:8 row_mask:0xf bank_mask:0xf
  s_nop 1
  v_max_f32_dpp v60, v60, v60 row_bcast:15 row_mask:0xa bank_mask:0xf
  s_nop 1
  v_max_f32_dpp v60, v60, v60 row_bcast:31 row_mask:0xc bank_mask:0xf
  s_nop 0
  v_readlane_b32 s32, v60, 63
  s_nop 1
  v_mov_b32 v60, s32
  v_mul_f32 v62, s33, v60
  v_fma_f32 v36, v36, s33, -v62
  v_fma_f32 v37, v37, s33, -v62
  v_fma_f32 v38, v38, s33, -v62
  v_fma_f32 v39, v39, s33, -v62
  v_fma_f32 v40, v40, s33, -v62
  v_fma_f32 v41, v41, s33, -v62
  v_fma_f32 v42, v42, s33, -v62
  v_fma_f32 v43, v43, s33, -v62
  v_exp_f32 v36, v36
  v_exp_f32 v37, v37
  v_exp_f32 v38, v38
  v_exp_f32 v39, v39
  v_exp_f32 v40, v40
  v_exp_f32 v41, v41
  v_exp_f32 v42, v42
  v_exp_f32 v43, v43
  s_waitcnt vmcnt(7)
  buffer_load_dwordx4 v[144:147], v2, s[8:11], s20 offen offset:2048 nt
  s_nop 0
  v_add_f32 v61, v36, v37
  v_add_f32 v62, v38, v39
  v_add_f32 v63, v40, v41
  v_add_f32 v61, v61, v42
  v_add_f32 v62, v62, v43
  v_add_f32 v61, v61, v63
  v_add_f32 v61, v61, v62
  v_cvt_pk_bf16_f32 v36, v36, v36
  v_cvt_pk_bf16_f32 v37, v37, v37
  v_cvt_pk_bf16_f32 v38, v38, v38
  v_cvt_pk_bf16_f32 v39, v39, v39
  v_cvt_pk_bf16_f32 v40, v40, v40
  v_cvt_pk_bf16_f32 v41, v41, v41
  v_cvt_pk_bf16_f32 v42, v42, v42
  v_cvt_pk_bf16_f32 v43, v43, v43
  s_nop 1
  v_add_f32_dpp v61, v61, v61 row_ror:4 row_mask:0xf bank_mask:0xf
  s_nop 1
  v_add_f32_dpp v61, v61, v61 row_ror:8 row_mask:0xf bank_mask:0xf
  s_nop 1
  v_add_f32_dpp v61, v61, v61 row_bcast:15 row_mask:0xa bank_mask:0xf
  s_nop 1
  v_add_f32_dpp v61, v61, v61 row_bcast:31 row_mask:0xc bank_mask:0xf
  s_mov_b32 exec_lo, 0
  s_mov_b32 exec_hi, 0x80000000
  ds_write_b64 v52, v[60:61] offset:448
  ds_add_u32 v57, v53 offset:404
  s_mov_b64 exec, -1
  v_and_b32_dpp v12, v36, v3 row_newbcast:0 row_mask:0xf bank_mask:0xf
  v_and_b32_dpp v13, v36, v4 row_newbcast:0 row_mask:0xf bank_mask:0xf
  v_and_b32_dpp v14, v36, v5 row_newbcast:0 row_mask:0xf bank_mask:0xf
  v_and_b32_dpp v15, v36, v6 row_newbcast:0 row_mask:0xf bank_mask:0xf
  s_waitcnt vmcnt(7)
  buffer_load_dwordx4 v[148:151], v2, s[8:11], s21 offen offset:3072 nt
  v_and_b32_dpp v16, v36, v3 row_newbcast:4 row_mask:0xf bank_mask:0xf
  v_and_b32_dpp v17, v36, v4 row_newbcast:4 row_mask:0xf bank_mask:0xf
  v_and_b32_dpp v18, v36, v5 row_newbcast:4 row_mask:0xf bank_mask:0xf
  v_and_b32_dpp v19, v36, v6 row_newbcast:4 row_mask:0xf bank_mask:0xf
  v_mfma_f32_16x16x32_bf16 v[8:11], v[12:15], v[64:67], 0
  v_and_b32_dpp v12, v36, v3 row_newbcast:8 row_mask:0xf bank_mask:0xf
  v_and_b32_dpp v13, v36, v4 row_newbcast:8 row_mask:0xf bank_mask:0xf
  v_and_b32_dpp v14, v36, v5 row_newbcast:8 row_mask:0xf bank_mask:0xf
  v_and_b32_dpp v15, v36, v6 row_newbcast:8 row_mask:0xf bank_mask:0xf
  v_mfma_f32_16x16x32_bf16 v[8:11], v[16:19], v[68:71], v[8:11]
  v_and_b32_dpp v16, v36, v3 row_newbcast:12 row_mask:0xf bank_mask:0xf
  v_and_b32_dpp v17, v36, v4 row_newbcast:12 row_mask:0xf bank_mask:0xf
  v_and_b32_dpp v18, v36, v5 row_newbcast:12 row_mask:0xf bank_mask:0xf
  v_and_b32_dpp v19, v36, v6 row_newbcast:12 row_mask:0xf bank_mask:0xf
  v_mfma_f32_16x16x32_bf16 v[8:11], v[12:15], v[72:75], v[8:11]
  v_and_b32_dpp v12, v37, v3 row_newbcast:0 row_mask:0xf bank_mask:0xf
  v_and_b32_dpp v13, v37, v4 row_newbcast:0 row_mask:0xf bank_mask:0xf
  v_and_b32_dpp v14, v37, v5 row_newbcast:0 row_mask:0xf bank_mask:0xf
  v_and_b32_dpp v15, v37, v6 row_newbcast:0 row_mask:0xf bank_mask:0xf
  v_mfma_f32_16x16x32_bf16 v[8:11], v[16:19], v[76:79], v[8:11]
  v_and_b32_dpp v16, v37, v3 row_newbcast:4 row_mask:0xf bank_mask:0xf
  v_and_b32_dpp v17, v37, v4 row_newbcast:4 row_mask:0xf bank_mask:0xf
  v_and_b32_dpp v18, v37, v5 row_newbcast:4 row_mask:0xf bank_mask:0xf
  v_and_b32_dpp v19, v37, v6 row_newbcast:4 row_mask:0xf bank_mask:0xf
  v_mfma_f32_16x16x32_bf16 v[8:11], v[12:15], v[80:83], v[8:11]
  v_and_b32_dpp v12, v37, v3 row_newbcast:8 row_mask:0xf bank_mask:0xf
  v_and_b32_dpp v13, v37, v4 row_newbcast:8 row_mask:0xf bank_mask:0xf
  v_and_b32_dpp v14, v37, v5 row_newbcast:8 row_mask:0xf bank_mask:0xf
  v_and_b32_dpp v15, v37, v6 row_newbcast:8 row_mask:0xf bank_mask:0xf
  v_mfma_f32_16x16x32_bf16 v[8:11], v[16:19], v[84:87], v[8:11]
  v_and_b32_dpp v16, v37, v3 row_newbcast:12 row_mask:0xf bank_mask:0xf
  v_and_b32_dpp v17, v37, v4 row_newbcast:12 row_mask:0xf bank_mask:0xf
  v_and_b32_dpp v18, v37, v5 row_newbcast:12 row_mask:0xf bank_mask:0xf
  v_and_b32_dpp v19, v37, v6 row_newbcast:12 row_mask:0xf bank_mask:0xf
  v_mfma_f32_16x16x32_bf16 v[8:11], v[12:15], v[88:91], v[8:11]
  v_and_b32_dpp v12, v38, v3 row_newbcast:0 row_mask:0xf bank_mask:0xf
  v_and_b32_dpp v13, v38, v4 row_newbcast:0 row_mask:0xf bank_mask:0xf
  v_and_b32_dpp v14, v38, v5 row_newbcast:0 row_mask:0xf bank_mask:0xf
  v_and_b32_dpp v15, v38, v6 row_newbcast:0 row_mask:0xf bank_mask:0xf
  v_mfma_f32_16x16x32_bf16 v[8:11], v[16:19], v[92:95], v[8:11]
  v_and_b32_dpp v16, v38, v3 row_newbcast:4 row_mask:0xf bank_mask:0xf
  v_and_b32_dpp v17, v38, v4 row_newbcast:4 row_mask:0xf bank_mask:0xf
  v_and_b32_dpp v18, v38, v5 row_newbcast:4 row_mask:0xf bank_mask:0xf
  v_and_b32_dpp v19, v38, v6 row_newbcast:4 row_mask:0xf bank_mask:0xf
  v_mfma_f32_16x16x32_bf16 v[8:11], v[12:15], v[96:99], v[8:11]
  v_and_b32_dpp v12, v38, v3 row_newbcast:8 row_mask:0xf bank_mask:0xf
  v_and_b32_dpp v13, v38, v4 row_newbcast:8 row_mask:0xf bank_mask:0xf
  v_and_b32_dpp v14, v38, v5 row_newbcast:8 row_mask:0xf bank_mask:0xf
  v_and_b32_dpp v15, v38, v6 row_newbcast:8 row_mask:0xf bank_mask:0xf
  v_mfma_f32_16x16x32_bf16 v[8:11], v[16:19], v[100:103], v[8:11]
  v_and_b32_dpp v16, v38, v3 row_newbcast:12 row_mask:0xf bank_mask:0xf
  v_and_b32_dpp v17, v38, v4 row_newbcast:12 row_mask:0xf bank_mask:0xf
  v_and_b32_dpp v18, v38, v5 row_newbcast:12 row_mask:0xf bank_mask:0xf
  v_and_b32_dpp v19, v38, v6 row_newbcast:12 row_mask:0xf bank_mask:0xf
  v_mfma_f32_16x16x32_bf16 v[8:11], v[12:15], v[104:107], v[8:11]
  v_and_b32_dpp v12, v39, v3 row_newbcast:0 row_mask:0xf bank_mask:0xf
  v_and_b32_dpp v13, v39, v4 row_newbcast:0 row_mask:0xf bank_mask:0xf
  v_and_b32_dpp v14, v39, v5 row_newbcast:0 row_mask:0xf bank_mask:0xf
  v_and_b32_dpp v15, v39, v6 row_newbcast:0 row_mask:0xf bank_mask:0xf
  v_mfma_f32_16x16x32_bf16 v[8:11], v[16:19], v[108:111], v[8:11]
  v_and_b32_dpp v16, v39, v3 row_newbcast:4 row_mask:0xf bank_mask:0xf
  v_and_b32_dpp v17, v39, v4 row_newbcast:4 row_mask:0xf bank_mask:0xf
  v_and_b32_dpp v18, v39, v5 row_newbcast:4 row_mask:0xf bank_mask:0xf
  v_and_b32_dpp v19, v39, v6 row_newbcast:4 row_mask:0xf bank_mask:0xf
  v_mfma_f32_16x16x32_bf16 v[8:11], v[12:15], v[112:115], v[8:11]
  v_and_b32_dpp v12, v39, v3 row_newbcast:8 row_mask:0xf bank_mask:0xf
  v_and_b32_dpp v13, v39, v4 row_newbcast:8 row_mask:0xf bank_mask:0xf
  v_and_b32_dpp v14, v39, v5 row_newbcast:8 row_mask:0xf bank_mask:0xf
  v_and_b32_dpp v15, v39, v6 row_newbcast:8 row_mask:0xf bank_mask:0xf
  v_mfma_f32_16x16x32_bf16 v[8:11], v[16:19], v[116:119], v[8:11]
  s_waitcnt vmcnt(7)
  buffer_load_dwordx4 v[152:155], v2, s[8:11], s22 offen offset:0 nt
  v_and_b32_dpp v16, v39, v3 row_newbcast:12 row_mask:0xf bank_mask:0xf
  v_and_b32_dpp v17, v39, v4 row_newbcast:12 row_mask:0xf bank_mask:0xf
  v_and_b32_dpp v18, v39, v5 row_newbcast:12 row_mask:0xf bank_mask:0xf
  v_and_b32_dpp v19, v39, v6 row_newbcast:12 row_mask:0xf bank_mask:0xf
  v_mfma_f32_16x16x32_bf16 v[8:11], v[12:15], v[120:123], v[8:11]
  s_waitcnt vmcnt(7)
  buffer_load_dwordx4 v[156:159], v2, s[8:11], s23 offen offset:1024 nt
  v_and_b32_dpp v12, v40, v3 row_newbcast:0 row_mask:0xf bank_mask:0xf
  v_and_b32_dpp v13, v40, v4 row_newbcast:0 row_mask:0xf bank_mask:0xf
  v_and_b32_dpp v14, v40, v5 row_newbcast:0 row_mask:0xf bank_mask:0xf
  v_and_b32_dpp v15, v40, v6 row_newbcast:0 row_mask:0xf bank_mask:0xf
  v_mfma_f32_16x16x32_bf16 v[8:11], v[16:19], v[124:127], v[8:11]
  s_waitcnt vmcnt(7)
  buffer_load_dwordx4 v[160:163], v2, s[8:11], s16 offen offset:3072 nt
  v_and_b32_dpp v16, v40, v3 row_newbcast:4 row_mask:0xf bank_mask:0xf
  v_and_b32_dpp v17, v40, v4 row_newbcast:4 row_mask:0xf bank_mask:0xf
  v_and_b32_dpp v18, v40, v5 row_newbcast:4 row_mask:0xf bank_mask:0xf
  v_and_b32_dpp v19, v40, v6 row_newbcast:4 row_mask:0xf bank_mask:0xf
  v_mfma_f32_16x16x32_bf16 v[8:11], v[12:15], v[128:131], v[8:11]
  s_waitcnt vmcnt(7)
  buffer_load_dwordx4 v[164:167], v2, s[8:11], s17 offen offset:0 nt
  v_and_b32_dpp v12, v40, v3 row_newbcast:8 row_mask:0xf bank_mask:0xf
  v_and_b32_dpp v13, v40, v4 row_newbcast:8 row_mask:0xf bank_mask:0xf
  v_and_b32_dpp v14, v40, v5 row_newbcast:8 row_mask:0xf bank_mask:0xf
  v_and_b32_dpp v15, v40, v6 row_newbcast:8 row_mask:0xf bank_mask:0xf
  v_mfma_f32_16x16x32_bf16 v[8:11], v[16:19], v[132:135], v[8:11]
  s_waitcnt vmcnt(7)
  buffer_load_dwordx4 v[168:171], v2, s[8:11], s18 offen offset:1024 nt
  v_and_b32_dpp v16, v40, v3 row_newbcast:12 row_mask:0xf bank_mask:0xf
  v_and_b32_dpp v17, v40, v4 row_newbcast:12 row_mask:0xf bank_mask:0xf
  v_and_b32_dpp v18, v40, v5 row_newbcast:12 row_mask:0xf bank_mask:0xf
  v_and_b32_dpp v19, v40, v6 row_newbcast:12 row_mask:0xf bank_mask:0xf
  v_mfma_f32_16x16x32_bf16 v[8:11], v[12:15], v[136:139], v[8:11]
  s_waitcnt vmcnt(7)
  buffer_load_dwordx4 v[172:175], v2, s[8:11], s19 offen offset:2048 nt
  v_and_b32_dpp v12, v41, v3 row_newbcast:0 row_mask:0xf bank_mask:0xf
  v_and_b32_dpp v13, v41, v4 row_newbcast:0 row_mask:0xf bank_mask:0xf
  v_and_b32_dpp v14, v41, v5 row_newbcast:0 row_mask:0xf bank_mask:0xf
  v_and_b32_dpp v15, v41, v6 row_newbcast:0 row_mask:0xf bank_mask:0xf
  v_mfma_f32_16x16x32_bf16 v[8:11], v[16:19], v[140:143], v[8:11]
  s_waitcnt vmcnt(7)
  buffer_load_dwordx4 v[176:179], v2, s[8:11], s20 offen offset:3072 nt
  v_and_b32_dpp v16, v41, v3 row_newbcast:4 row_mask:0xf bank_mask:0xf
  v_and_b32_dpp v17, v41, v4 row_newbcast:4 row_mask:0xf bank_mask:0xf
  v_and_b32_dpp v18, v41, v5 row_newbcast:4 row_mask:0xf bank_mask:0xf
  v_and_b32_dpp v19, v41, v6 row_newbcast:4 row_mask:0xf bank_mask:0xf
  v_mfma_f32_16x16x32_bf16 v[8:11], v[12:15], v[144:147], v[8:11]
  s_waitcnt vmcnt(7)
  buffer_load_dwordx4 v[180:183], v2, s[8:11], s21 offen offset:0 nt
  v_and_b32_dpp v12, v41, v3 row_newbcast:8 row_mask:0xf bank_mask:0xf
  v_and_b32_dpp v13, v41, v4 row_newbcast:8 row_mask:0xf bank_mask:0xf
  v_and_b32_dpp v14, v41, v5 row_newbcast:8 row_mask:0xf bank_mask:0xf
  v_and_b32_dpp v15, v41, v6 row_newbcast:8 row_mask:0xf bank_mask:0xf
  v_mfma_f32_16x16x32_bf16 v[8:11], v[16:19], v[148:151], v[8:11]
  s_waitcnt vmcnt(7)
  buffer_load_dwordx4 v[184:187], v2, s[8:11], s22 offen offset:1024 nt
  v_and_b32_dpp v16, v41, v3 row_newbcast:12 row_mask:0xf bank_mask:0xf
  v_and_b32_dpp v17, v41, v4 row_newbcast:12 row_mask:0xf bank_mask:0xf
  v_and_b32_dpp v18, v41, v5 row_newbcast:12 row_mask:0xf bank_mask:0xf
  v_and_b32_dpp v19, v41, v6 row_newbcast:12 row_mask:0xf bank_mask:0xf
  v_mfma_f32_16x16x32_bf16 v[8:11], v[12:15], v[152:155], v[8:11]
  s_waitcnt vmcnt(7)
  buffer_load_dwordx4 v[188:191], v2, s[8:11], s23 offen offset:2048 nt
  s_mov_b64 exec, 1
  ds_add_u32 v57, v53 offset:388
  s_mov_b64 exec, -1
  v_and_b32_dpp v12, v42, v3 row_newbcast:0 row_mask:0xf bank_mask:0xf
  v_and_b32_dpp v13, v42, v4 row_newbcast:0 row_mask:0xf bank_mask:0xf
  v_and_b32_dpp v14, v42, v5 row_newbcast:0 row_mask:0xf bank_mask:0xf
  v_and_b32_dpp v15, v42, v6 row_newbcast:0 row_mask:0xf bank_mask:0xf
  v_mfma_f32_16x16x32_bf16 v[8:11], v[16:19], v[156:159], v[8:11]
  v_and_b32_dpp v16, v42, v3 row_newbcast:4 row_mask:0xf bank_mask:0xf
  v_and_b32_dpp v17, v42, v4 row_newbcast:4 row_mask:0xf bank_mask:0xf
  v_and_b32_dpp v18, v42, v5 row_newbcast:4 row_mask:0xf bank_mask:0xf
  v_and_b32_dpp v19, v42, v6 row_newbcast:4 row_mask:0xf bank_mask:0xf
  s_waitcnt vmcnt(7)
  v_mfma_f32_16x16x32_bf16 v[8:11], v[12:15], v[160:163], v[8:11]
  v_and_b32_dpp v12, v42, v3 row_newbcast:8 row_mask:0xf bank_mask:0xf
  v_and_b32_dpp v13, v42, v4 row_newbcast:8 row_mask:0xf bank_mask:0xf
  v_and_b32_dpp v14, v42, v5 row_newbcast:8 row_mask:0xf bank_mask:0xf
  v_and_b32_dpp v15, v42, v6 row_newbcast:8 row_mask:0xf bank_mask:0xf
  s_waitcnt vmcnt(6)
  v_mfma_f32_16x16x32_bf16 v[8:11], v[16:19], v[164:167], v[8:11]
  v_and_b32_dpp v16, v42, v3 row_newbcast:12 row_mask:0xf bank_mask:0xf
  v_and_b32_dpp v17, v42, v4 row_newbcast:12 row_mask:0xf bank_mask:0xf
  v_and_b32_dpp v18, v42, v5 row_newbcast:12 row_mask:0xf bank_mask:0xf
  v_and_b32_dpp v19, v42, v6 row_newbcast:12 row_mask:0xf bank_mask:0xf
  s_waitcnt vmcnt(5)
  v_mfma_f32_16x16x32_bf16 v[8:11], v[12:15], v[168:171], v[8:11]
  v_and_b32_dpp v12, v43, v3 row_newbcast:0 row_mask:0xf bank_mask:0xf
  v_and_b32_dpp v13, v43, v4 row_newbcast:0 row_mask:0xf bank_mask:0xf
  v_and_b32_dpp v14, v43, v5 row_newbcast:0 row_mask:0xf bank_mask:0xf
  v_and_b32_dpp v15, v43, v6 row_newbcast:0 row_mask:0xf bank_mask:0xf
  s_waitcnt vmcnt(4)
  v_mfma_f32_16x16x32_bf16 v[8:11], v[16:19], v[172:175], v[8:11]
  s_mov_b32 s32, 0
L_wait_f:
  ds_read_b32 v55, v57 offset:420
  ds_read_b32 v54, v52 offset:256
  s_waitcnt lgkmcnt(0)
  v_readfirstlane_b32 s31, v55
  s_cmp_lg_u32 s31, 0
  s_cbranch_scc1 L_have_f
  s_sleep 1
  s_add_u32 s32, s32, 1
  s_cmp_lt_u32 s32, 6400000
  s_cbranch_scc1 L_wait_f
L_have_f:
  v_and_b32_dpp v16, v43, v3 row_newbcast:4 row_mask:0xf bank_mask:0xf
  v_and_b32_dpp v17, v43, v4 row_newbcast:4 row_mask:0xf bank_mask:0xf
  v_and_b32_dpp v18, v43, v5 row_newbcast:4 row_mask:0xf bank_mask:0xf
  v_and_b32_dpp v19, v43, v6 row_newbcast:4 row_mask:0xf bank_mask:0xf
  s_waitcnt vmcnt(3)
  v_mfma_f32_16x16x32_bf16 v[8:11], v[12:15], v[176:179], v[8:11]
  v_and_b32_dpp v12, v43, v3 row_newbcast:8 row_mask:0xf bank_mask:0xf
  v_and_b32_dpp v13, v43, v4 row_newbcast:8 row_mask:0xf bank_mask:0xf
  v_and_b32_dpp v14, v43, v5 row_newbcast:8 row_mask:0xf bank_mask:0xf
  v_and_b32_dpp v15, v43, v6 row_newbcast:8 row_mask:0xf bank_mask:0xf
  s_waitcnt vmcnt(2)
  v_mfma_f32_16x16x32_bf16 v[8:11], v[16:19], v[180:183], v[8:11]
  v_and_b32_dpp v16, v43, v3 row_newbcast:12 row_mask:0xf bank_mask:0xf
  v_and_b32_dpp v17, v43, v4 row_newbcast:12 row_mask:0xf bank_mask:0xf
  v_and_b32_dpp v18, v43, v5 row_newbcast:12 row_mask:0xf bank_mask:0xf
  v_and_b32_dpp v19, v43, v6 row_newbcast:12 row_mask:0xf bank_mask:0xf
  s_waitcnt vmcnt(1)
  v_mfma_f32_16x16x32_bf16 v[8:11], v[12:15], v[184:187], v[8:11]
  s_waitcnt vmcnt(0)
  v_mfma_f32_16x16x32_bf16 v[8:11], v[16:19], v[188:191], v[8:11]
  s_mov_b32 exec_hi, 0
  s_nop 6
  v_mul_f32 v8, v8, v54
  v_mul_f32 v9, v9, v54
  v_mul_f32 v10, v10, v54
  v_mul_f32 v11, v11, v54
  ds_write_b128 v56, v[8:11] offset:4608
  s_mov_b32 exec_lo, 1
  ds_add_rtn_u32 v60, v57, v53 offset:416
  s_mov_b32 exec_lo, -1
  ds_read_b128 v[64:67], v58 offset:4608
  ds_read_b128 v[68:71], v58 offset:5120
  ds_read_b128 v[72:75], v58 offset:5632
  ds_read_b128 v[76:79], v58 offset:6144
  s_waitcnt lgkmcnt(4)
  v_readfirstlane_b32 s31, v60
  s_cmp_lt_u32 s31, 3
  s_cbranch_scc1 L_not_last
  s_waitcnt lgkmcnt(2)
  v_pk_add_f32 v[64:65], v[64:65], v[68:69]
  v_pk_add_f32 v[66:67], v[66:67], v[70:71]
  s_waitcnt lgkmcnt(0)
  v_pk_add_f32 v[72:73], v[72:73], v[76:77]
  v_pk_add_f32 v[74:75], v[74:75], v[78:79]
  s_cmp_eq_u32 s39, 1
  v_pk_add_f32 v[64:65], v[64:65], v[72:73]
  v_pk_add_f32 v[66:67], v[66:67], v[74:75]
  v_and_or_b32 v64, v64, s28, v7
  v_and_or_b32 v65, v65, s28, v7
  v_and_or_b32 v66, v66, s28, v7
  v_and_or_b32 v67, v67, s28, v7
  s_cbranch_scc1 L_far_1
  buffer_store_dwordx4 v[64:67], v58, s[12:15], s37 offen
L_far_1_d:
  ds_write_b32 v57, v53 offset:432
L_not_last:
  s_waitcnt lgkmcnt(0)
  s_mov_b64 exec, -1
  s_cmp_lg_u32 s38, 0
  s_cbranch_scc1 L_exit
  v_and_b32 v21, 1, v0
  v_lshlrev_b32 v21, 4, v21
  v_lshrrev_b32 v22, 1, v0
  v_lshl_or_b32 v23, v22, 7, v21
  s_lshr_b32 s35, s58, 1
  s_lshl_b32 s35, s35, 10
  s_and_b32 s29, s58, 1
  s_lshl_b32 s29, s29, 5
  s_add_u32 s35, s35, s29
  s_add_u32 s35, s35, 1703936
  s_mov_b64 s[8:9], s[50:51]
  s_movk_i32 s10, 1024
  v_lshlrev_b32 v20, 16, v50
  v_lshl_or_b32 v2, v22, 11, v21
  s_lshl_b32 s30, s58, 5
  s_add_u32 s30, s30, 458752
  v_cmp_gt_u32 vcc, 16, v0
  v_mov_b32 v72, 0
  v_mov_b32 v73, 0
  v_mov_b32 v74, 0
  v_mov_b32 v75, 0
  v_cndmask_b32 v25, 0, v7, vcc
  s_mov_b32 s57, 0
  s_mov_b32 s63, 0
L_x_wait:
  s_sleep 1
  ds_read_b32 v60, v57 offset:408
  s_add_u32 s63, s63, 1
  s_waitcnt lgkmcnt(0)
  v_readfirstlane_b32 s31, v60
  s_cmp_gt_u32 s63, 1600000
  s_cbranch_scc1 L_x_wait_x
  s_cmp_lt_u32 s31, 1
  s_cbranch_scc1 L_x_wait
L_x_wait_x:
  s_setprio 3
L_g_poll:
  s_mov_b64 exec, 0xffff
  buffer_load_dwordx4 v[72:75], v23, s[12:15], s35 offen sc1
  s_mov_b64 exec, -1
  buffer_load_dwordx4 v[64:67], v2, s[12:15], s30 offen sc1
  s_waitcnt vmcnt(1)
  v_xor_b32 v72, v72, v25
  v_xor_b32 v73, v73, v25
  v_xor_b32 v74, v74, v25
  v_xor_b32 v75, v75, v25
  v_or3_b32 v60, v72, v73, v74
  v_or_b32 v60, v60, v75
  v_and_b32 v60, 4095, v60
  v_cmp_ne_u32 vcc, 0, v60
  s_cbranch_vccz L_g_ok
  s_sleep 2
  s_add_u32 s57, s57, 1
  s_cmp_lt_u32 s57, 200000
  s_cbranch_scc1 L_g_poll
L_g_ok:
  s_nop 0
  v_permlane32_swap_b32 v72, v74
  v_permlane32_swap_b32 v73, v75
  v_add_f32 v72, v72, v74
  v_add_f32 v73, v73, v75
  s_nop 1
  v_permlane16_swap_b32 v72, v73
  v_add_f32 v72, v72, v73
  s_nop 1
  v_add_f32_dpp v72, v72, v72 row_ror:2 row_mask:0xf bank_mask:0xf
  s_nop 1
  v_add_f32_dpp v72, v72, v72 row_ror:4 row_mask:0xf bank_mask:0xf
  s_nop 1
  v_add_f32_dpp v72, v72, v72 row_ror:8 row_mask:0xf bank_mask:0xf
  v_cvt_pk_bf16_f32 v72, v72, v72
  v_and_b32 v72, 0xffff0000, v72
  v_mul_f32 v24, 0xbfb8aa3b, v72
  v_exp_f32 v24, v24
  s_mov_b32 s57, 0
  v_add_f32 v24, 1.0, v24
  v_rcp_f32 v24, v24
  s_nop 0
  v_mul_f32 v24, v72, v24
  v_cvt_pk_bf16_f32 v24, v24, v24
  v_and_b32 v24, 0xffff0000, v24
  buffer_load_dwordx4 v[80:83], v2, s[12:15], s30 offen sc1
  s_sleep 2
L_x_poll:
  buffer_load_dwordx4 v[84:87], v2, s[12:15], s30 offen sc1
  s_waitcnt vmcnt(2)
  v_xor_b32 v100, v64, v7
  v_xor_b32 v101, v65, v7
  v_xor_b32 v102, v66, v7
  v_xor_b32 v103, v67, v7
  v_or3_b32 v60, v100, v101, v102
  v_bitop3_b32 v60, v60, v103, s28 bitop3:0x54
  v_cmp_ne_u32 vcc, 0, v60
  s_cbranch_vccz L_x_ok
  s_sleep 2
  buffer_load_dwordx4 v[64:67], v2, s[12:15], s30 offen sc1
  s_waitcnt vmcnt(2)
  v_xor_b32 v100, v80, v7
  v_xor_b32 v101, v81, v7
  v_xor_b32 v102, v82, v7
  v_xor_b32 v103, v83, v7
  v_or3_b32 v60, v100, v101, v102
  v_bitop3_b32 v60, v60, v103, s28 bitop3:0x54
  v_cmp_ne_u32 vcc, 0, v60
  s_cbranch_vccz L_x_ok
  s_sleep 2
  buffer_load_dwordx4 v[80:83], v2, s[12:15], s30 offen sc1
  s_waitcnt vmcnt(2)
  v_xor_b32 v100, v84, v7
  v_xor_b32 v101, v85, v7
  v_xor_b32 v102, v86, v7
  v_xor_b32 v103, v87, v7
  v_or3_b32 v60, v100, v101, v102
  v_bitop3_b32 v60, v60, v103, s28 bitop3:0x54
  v_cmp_ne_u32 vcc, 0, v60
  s_cbranch_vccz L_x_ok
  s_sleep 2
  s_add_u32 s57, s57, 1
  s_cmp_lt_u32 s57, 200000
  s_cbranch_scc1 L_x_poll
L_x_ok:
  v_permlane32_swap_b32 v100, v102
  v_permlane32_swap_b32 v101, v103
  v_add_f32 v104, v100, v102
  v_add_f32 v105, v101, v103
  s_nop 1
  v_permlane16_swap_b32 v104, v105
  v_add_f32 v104, v104, v105
  s_nop 1
  v_add_f32_dpp v104, v104, v104 row_ror:2 row_mask:0xf bank_mask:0xf
  s_nop 1
  v_add_f32_dpp v104, v104, v104 row_ror:4 row_mask:0xf bank_mask:0xf
  s_nop 1
  v_add_f32_dpp v104, v104, v104 row_ror:8 row_mask:0xf bank_mask:0xf
  v_cvt_pk_bf16_f32 v104, v104, v104
  v_and_b32 v104, 0xffff0000, v104
  v_mul_f32 v104, v104, v24
  v_cvt_pk_bf16_f32 v104, v104, v104
  v_and_b32 v104, 0xffff0000, v104
  v_add_f32 v104, v104, v20
  s_mov_b32 exec_lo, 0x00030003
  s_mov_b32 exec_hi, 0x00030003
  v_cvt_pk_bf16_f32 v104, v104, v104
  buffer_store_short v104, v51, s[8:11], 0 offen
  s_cmp_lg_u32 s58, 0
  s_cbranch_scc1 L_exit
  s_add_u32 s26, s26, 1
  v_mov_b32 v38, s26
  s_mov_b64 exec, 1
  buffer_store_dword v38, off, s[12:15], 0
L_exit:
L_end:
  s_endpgm
L_tile:
  s_waitcnt lgkmcnt(0)
  s_setprio 2
  s_load_dword s26, s[54:55], 0
  s_mov_b64 s[12:13], s[54:55]
  s_mov_b32 s14, 2097152
  s_mov_b32 s15, 0x20000
  s_mov_b64 s[16:17], s[40:41]
  s_mov_b32 s18, 0x400000
  s_mov_b32 s19, 0x20000
  s_mov_b32 s28, 0xfffff000
  v_lshlrev_b32 v31, 5, v29
  v_lshl_or_b32 v31, v28, 4, v31
  v_mov_b32 v57, 0
  v_bfe_u32 v60, v0, 1, 2
  v_and_b32 v61, 1, v0
  v_lshlrev_b32 v61, 4, v61
  v_mov_b32 v62, 0xffff
  v_lshlrev_b32 v62, v61, v62
  v_cmp_eq_u32 vcc, 0, v60
  s_nop 1
  v_cndmask_b32 v3, 0, v62, vcc
  v_cmp_eq_u32 vcc, 1, v60
  s_nop 1
  v_cndmask_b32 v4, 0, v62, vcc
  v_cmp_eq_u32 vcc, 2, v60
  s_nop 1
  v_cndmask_b32 v5, 0, v62, vcc
  v_cmp_eq_u32 vcc, 3, v60
  s_nop 1
  v_cndmask_b32 v6, 0, v62, vcc
  s_waitcnt lgkmcnt(0)
  s_add_u32 s27, s26, 1
  s_and_b32 s27, s27, 4095
  v_mov_b32 v7, s27
  v_mov_b32 v53, 16
  s_mov_b64 exec, 1
  ds_add_u32 v57, v53 offset:388
  s_mov_b64 exec, -1
  s_lshl_b32 s29, s25, 5
  v_lshlrev_b32 v40, 3, v28
  v_add_u32 v40, s29, v40
  v_add_u32 v41, 4, v40
  s_lshl3_add_u32 s30, s24, s25
  s_lshl_b32 s61, s30, 10
  s_add_u32 s61, s61, 65536
  s_lshl_b32 s62, s30, 9
  s_add_u32 s62, s62, 327680
  s_getreg_b32 s43, hwreg(HW_REG_XCC_ID, 0, 4)
  s_lshl_b32 s43, s43, 8
  v_xor_b32 v43, s43, v7
  s_cmp_eq_u32 s3, 4
  s_cselect_b32 s43, s43, 0
  v_xor_b32 v42, s43, v7
  s_cselect_b32 s61, s61, s62
  s_add_u32 s62, s61, 512
  s_waitcnt vmcnt(16)
  v_lshlrev_b32 v16, 16, v8
  v_and_b32 v17, 0xffff0000, v8
  v_lshlrev_b32 v18, 16, v9
  v_and_b32 v19, 0xffff0000, v9
  v_lshlrev_b32 v20, 16, v10
  v_and_b32 v21, 0xffff0000, v10
  v_lshlrev_b32 v22, 16, v11
  v_and_b32 v23, 0xffff0000, v11
  v_add_f32 v24, v16, v17
  v_add_f32 v25, v18, v19
  v_add_f32 v26, v20, v21
  v_add_f32 v27, v22, v23
  v_add_f32 v24, v24, v25
  v_add_f32 v26, v26, v27
  v_add_f32 v24, v24, v26
  s_nop 1
  v_add_f32_dpp v24, v24, v24 row_ror:1 row_mask:0xf bank_mask:0xf
  s_nop 1
  v_add_f32_dpp v24, v24, v24 row_ror:2 row_mask:0xf bank_mask:0xf
  s_nop 1
  v_add_f32_dpp v24, v24, v24 row_ror:4 row_mask:0xf bank_mask:0xf
  s_nop 1
  v_add_f32_dpp v24, v24, v24 row_ror:8 row_mask:0xf bank_mask:0xf
  s_nop 1
  v_add_f32_dpp v24, v24, v24 row_bcast:15 row_mask:0xa bank_mask:0xf
  s_nop 1
  v_add_f32_dpp v24, v24, v24 row_bcast:31 row_mask:0xc bank_mask:0xf
  s_nop 0
  v_readlane_b32 s30, v24, 63
  s_nop 1
  v_mov_b32 v25, s30
  v_mul_f32 v25, 0x3b000000, v25
  v_sub_f32 v26, v16, v25
  v_mul_f32 v24, v26, v26
  v_sub_f32 v26, v17, v25
  v_fmac_f32 v24, v26, v26
  v_sub_f32 v26, v18, v25
  v_fmac_f32 v24, v26, v26
  v_sub_f32 v26, v19, v25
  v_fmac_f32 v24, v26, v26
  v_sub_f32 v26, v20, v25
  v_fmac_f32 v24, v26, v26
  v_sub_f32 v26, v21, v25
  v_fmac_f32 v24, v26, v26
  v_sub_f32 v26, v22, v25
  v_fmac_f32 v24, v26, v26
  v_sub_f32 v26, v23, v25
  v_fmac_f32 v24, v26, v26
  s_nop 1
  v_add_f32_dpp v24, v24, v24 row_ror:1 row_mask:0xf bank_mask:0xf
  s_nop 1
  v_add_f32_dpp v24, v24, v24 row_ror:2 row_mask:0xf bank_mask:0xf
  s_nop 1
  v_add_f32_dpp v24, v24, v24 row_ror:4 row_mask:0xf bank_mask:0xf
  s_nop 1
  v_add_f32_dpp v24, v24, v24 row_ror:8 row_mask:0xf bank_mask:0xf
  s_nop 1
  v_add_f32_dpp v24, v24, v24 row_bcast:15 row_mask:0xa bank_mask:0xf
  s_nop 1
  v_add_f32_dpp v24, v24, v24 row_bcast:31 row_mask:0xc bank_mask:0xf
  s_nop 0
  v_readlane_b32 s31, v24, 63
  s_nop 1
  v_mov_b32 v26, s31
  v_mul_f32 v26, 0x3b000000, v26
  v_cvt_pk_bf16_f32 v25, v25, v25
  v_and_b32 v25, 0xffff0000, v25
  v_cvt_pk_bf16_f32 v26, v26, v26
  v_and_b32 v26, 0xffff0000, v26
  v_add_f32 v26, 0x3727c5ac, v26
  v_cvt_pk_bf16_f32 v26, v26, v26
  v_and_b32 v26, 0xffff0000, v26
  v_sqrt_f32 v26, v26
  s_nop 0
  v_cvt_pk_bf16_f32 v26, v26, v26
  v_and_b32 v26, 0xffff0000, v26
  v_rcp_f32 v26, v26
  v_sub_f32 v16, v16, v25
  v_sub_f32 v17, v17, v25
  v_cvt_pk_bf16_f32 v27, v16, v17
  v_lshlrev_b32 v16, 16, v27
  v_and_b32 v17, 0xffff0000, v27
  v_mul_f32 v16, v16, v26
  v_mul_f32 v17, v17, v26
  v_cvt_pk_bf16_f32 v12, v16, v17
  v_sub_f32 v18, v18, v25
  v_sub_f32 v19, v19, v25
  v_cvt_pk_bf16_f32 v27, v18, v19
  v_lshlrev_b32 v18, 16, v27
  v_and_b32 v19, 0xffff0000, v27
  v_mul_f32 v18, v18, v26
  v_mul_f32 v19, v19, v26
  v_cvt_pk_bf16_f32 v13, v18, v19
  v_sub_f32 v20, v20, v25
  v_sub_f32 v21, v21, v25
  v_cvt_pk_bf16_f32 v27, v20, v21
  v_lshlrev_b32 v20, 16, v27
  v_and_b32 v21, 0xffff0000, v27
  v_mul_f32 v20, v20, v26
  v_mul_f32 v21, v21, v26
  v_cvt_pk_bf16_f32 v14, v20, v21
  v_sub_f32 v22, v22, v25
  v_sub_f32 v23, v23, v25
  v_cvt_pk_bf16_f32 v27, v22, v23
  v_lshlrev_b32 v22, 16, v27
  v_and_b32 v23, 0xffff0000, v27
  v_mul_f32 v22, v22, v26
  v_mul_f32 v23, v23, v26
  v_cvt_pk_bf16_f32 v15, v22, v23
  ds_bpermute_b32 v32, v40, v12
  ds_bpermute_b32 v36, v41, v12
  ds_bpermute_b32 v33, v40, v13
  ds_bpermute_b32 v37, v41, v13
  ds_bpermute_b32 v34, v40, v14
  ds_bpermute_b32 v38, v41, v14
  ds_bpermute_b32 v35, v40, v15
  ds_bpermute_b32 v39, v41, v15
  s_mov_b32 s40, 0x01000100
  s_mov_b32 s41, 0x03020302
  s_waitcnt lgkmcnt(0)
  v_perm_b32 v24, v32, v32, s40
  v_and_b32 v16, v24, v3
  v_and_b32 v17, v24, v4
  v_and_b32 v18, v24, v5
  v_and_b32 v19, v24, v6
  s_waitcnt vmcnt(15)
  s_nop 0
  v_mfma_f32_16x16x32_bf16 v[8:11], v[16:19], v[64:67], 0
  v_perm_b32 v24, v32, v32, s41
  v_and_b32 v20, v24, v3
  v_and_b32 v21, v24, v4
  v_and_b32 v22, v24, v5
  v_and_b32 v23, v24, v6
  s_waitcnt vmcnt(14)
  s_nop 0
  v_mfma_f32_16x16x32_bf16 v[8:11], v[20:23], v[68:71], v[8:11]
  v_perm_b32 v24, v33, v33, s40
  v_and_b32 v16, v24, v3
  v_and_b32 v17, v24, v4
  v_and_b32 v18, v24, v5
  v_and_b32 v19, v24, v6
  s_waitcnt vmcnt(13)
  s_nop 0
  v_mfma_f32_16x16x32_bf16 v[8:11], v[16:19], v[72:75], v[8:11]
  v_perm_b32 v24, v33, v33, s41
  v_and_b32 v20, v24, v3
  v_and_b32 v21, v24, v4
  v_and_b32 v22, v24, v5
  v_and_b32 v23, v24, v6
  s_waitcnt vmcnt(12)
  s_nop 0
  v_mfma_f32_16x16x32_bf16 v[8:11], v[20:23], v[76:79], v[8:11]
  v_perm_b32 v24, v34, v34, s40
  v_and_b32 v16, v24, v3
  v_and_b32 v17, v24, v4
  v_and_b32 v18, v24, v5
  v_and_b32 v19, v24, v6
  s_waitcnt vmcnt(11)
  s_nop 0
  v_mfma_f32_16x16x32_bf16 v[8:11], v[16:19], v[80:83], v[8:11]
  v_perm_b32 v24, v34, v34, s41
  v_and_b32 v20, v24, v3
  v_and_b32 v21, v24, v4
  v_and_b32 v22, v24, v5
  v_and_b32 v23, v24, v6
  s_waitcnt vmcnt(10)
  s_nop 0
  v_mfma_f32_16x16x32_bf16 v[8:11], v[20:23], v[84:87], v[8:11]
  v_perm_b32 v24, v35, v35, s40
  v_and_b32 v16, v24, v3
  v_and_b32 v17, v24, v4
  v_and_b32 v18, v24, v5
  v_and_b32 v19, v24, v6
  s_waitcnt vmcnt(9)
  s_nop 0
  v_mfma_f32_16x16x32_bf16 v[8:11], v[16:19], v[88:91], v[8:11]
  v_perm_b32 v24, v35, v35, s41
  v_and_b32 v20, v24, v3
  v_and_b32 v21, v24, v4
  v_and_b32 v22, v24, v5
  v_and_b32 v23, v24, v6
  s_waitcnt vmcnt(8)
  s_nop 0
  v_mfma_f32_16x16x32_bf16 v[8:11], v[20:23], v[92:95], v[8:11]
  v_perm_b32 v24, v36, v36, s40
  v_and_b32 v16, v24, v3
  v_and_b32 v17, v24, v4
  v_and_b32 v18, v24, v5
  v_and_b32 v19, v24, v6
  s_waitcnt vmcnt(7)
  s_nop 0
  v_mfma_f32_16x16x32_bf16 v[8:11], v[16:19], v[96:99], v[8:11]
  v_perm_b32 v24, v36, v36, s41
  v_and_b32 v20, v24, v3
  v_and_b32 v21, v24, v4
  v_and_b32 v22, v24, v5
  v_and_b32 v23, v24, v6
  s_waitcnt vmcnt(6)
  s_nop 0
  v_mfma_f32_16x16x32_bf16 v[8:11], v[20:23], v[100:103], v[8:11]
  v_perm_b32 v24, v37, v37, s40
  v_and_b32 v16, v24, v3
  v_and_b32 v17, v24, v4
  v_and_b32 v18, v24, v5
  v_and_b32 v19, v24, v6
  s_waitcnt vmcnt(5)
  s_nop 0
  v_mfma_f32_16x16x32_bf16 v[8:11], v[16:19], v[104:107], v[8:11]
  v_perm_b32 v24, v37, v37, s41
  v_and_b32 v20, v24, v3
  v_and_b32 v21, v24, v4
  v_and_b32 v22, v24, v5
  v_and_b32 v23, v24, v6
  s_waitcnt vmcnt(4)
  s_nop 0
  v_mfma_f32_16x16x32_bf16 v[8:11], v[20:23], v[108:111], v[8:11]
  v_perm_b32 v24, v38, v38, s40
  v_and_b32 v16, v24, v3
  v_and_b32 v17, v24, v4
  v_and_b32 v18, v24, v5
  v_and_b32 v19, v24, v6
  s_waitcnt vmcnt(3)
  s_nop 0
  v_mfma_f32_16x16x32_bf16 v[8:11], v[16:19], v[112:115], v[8:11]
  v_perm_b32 v24, v38, v38, s41
  v_and_b32 v20, v24, v3
  v_and_b32 v21, v24, v4
  v_and_b32 v22, v24, v5
  v_and_b32 v23, v24, v6
  s_waitcnt vmcnt(2)
  s_nop 0
  v_mfma_f32_16x16x32_bf16 v[8:11], v[20:23], v[116:119], v[8:11]
  v_perm_b32 v24, v39, v39, s40
  v_and_b32 v16, v24, v3
  v_and_b32 v17, v24, v4
  v_and_b32 v18, v24, v5
  v_and_b32 v19, v24, v6
  s_waitcnt vmcnt(1)
  s_nop 0
  v_mfma_f32_16x16x32_bf16 v[8:11], v[16:19], v[120:123], v[8:11]
  v_perm_b32 v24, v39, v39, s41
  v_and_b32 v20, v24, v3
  v_and_b32 v21, v24, v4
  v_and_b32 v22, v24, v5
  v_and_b32 v23, v24, v6
  s_waitcnt vmcnt(0)
  s_nop 0
  v_mfma_f32_16x16x32_bf16 v[8:11], v[20:23], v[124:127], v[8:11]
  s_nop 7
  v_and_b32 v12, s28, v8
  v_and_b32 v13, s28, v9
  v_and_b32 v14, s28, v10
  v_and_b32 v15, s28, v11
  v_sub_f32 v8, v8, v12
  v_sub_f32 v9, v9, v13
  v_sub_f32 v10, v10, v14
  v_sub_f32 v11, v11, v15
  v_or_b32 v12, v12, v42
  v_or_b32 v13, v13, v42
  v_or_b32 v14, v14, v42
  v_or_b32 v15, v15, v42
  v_and_or_b32 v8, v8, s28, v42
  v_and_or_b32 v9, v9, s28, v42
  v_and_or_b32 v10, v10, s28, v42
  v_and_or_b32 v11, v11, s28, v42
  s_mov_b32 exec_hi, 0
  buffer_store_dwordx4 v[12:15], v31, s[12:15], s61 offen
  s_mov_b64 exec, -1
  s_cmp_eq_u32 s3, 4
  s_cbranch_scc1 L_a0
  s_lshl_b32 s29, s59, 15
  s_add_u32 s29, s29, 65536
  v_and_b32 v2, 31, v0
  v_lshlrev_b32 v2, 10, v2
  s_mov_b32 s57, 0
  s_mov_b32 s63, 0
L_c_wait:
  s_sleep 8
  ds_read_b32 v60, v57 offset:396
  s_add_u32 s63, s63, 1
  s_waitcnt lgkmcnt(0)
  v_readfirstlane_b32 s31, v60
  s_cmp_gt_u32 s63, 1600000
  s_cbranch_scc1 L_c_wait_x
  s_cmp_lt_u32 s31, 2
  s_cbranch_scc1 L_c_wait
L_c_wait_x:
L_c_poll:
  buffer_load_dwordx4 v[64:67], v2, s[12:15], s29 offen sc1 nt
  s_waitcnt vmcnt(0)
  v_xor_b32 v64, v64, v43
  v_xor_b32 v65, v65, v43
  v_xor_b32 v66, v66, v43
  v_xor_b32 v67, v67, v43
  v_or3_b32 v60, v64, v65, v66
  v_or_b32 v60, v60, v67
  v_and_b32 v60, 4095, v60
  v_cmp_ne_u32 vcc, 0, v60
  v_mov_b32 v61, 2
  s_cbranch_vccz L_c_done
  s_sleep 8
  s_add_u32 s57, s57, 1
  s_cmp_lt_u32 s57, 3
  s_cbranch_scc1 L_c_poll
  s_mov_b32 exec_hi, 0
  buffer_store_dwordx4 v[12:15], v31, s[12:15], s61 offen sc1
  s_mov_b64 exec, -1
  v_mov_b32 v61, 1
L_c_done:
  ds_write_b32 v57, v61 offset:392
  s_branch L_tail
L_a0:
  s_mov_b32 exec_hi, 0
  buffer_store_dwordx4 v[8:11], v31, s[12:15], s62 offen
  s_mov_b64 exec, -1
  s_lshl_b32 s44, s24, 13
  s_add_u32 s44, s44, 65536
  s_add_u32 s45, s44, 0x1000
  s_mov_b32 s57, 0
  s_mov_b32 s63, 0
L_e_wait:
  s_sleep 1
  ds_read_b32 v60, v57 offset:388
  s_add_u32 s63, s63, 1
  s_waitcnt lgkmcnt(0)
  v_readfirstlane_b32 s31, v60
  s_cmp_gt_u32 s63, 1600000
  s_cbranch_scc1 L_e_wait_x
  s_cmp_lt_u32 s31, 64
  s_cbranch_scc1 L_e_wait
L_e_wait_x:
  s_mov_b32 s63, 0
L_q_wait:
  s_sleep 4
  ds_read_b32 v60, v57 offset:400
  s_add_u32 s63, s63, 1
  s_waitcnt lgkmcnt(0)
  v_readfirstlane_b32 s31, v60
  s_cmp_gt_u32 s63, 1600000
  s_cbranch_scc1 L_q_wait_x
  s_cmp_lt_u32 s31, 2
  s_cbranch_scc1 L_q_wait
L_q_wait_x:
L_q_poll:
  buffer_load_dwordx4 v[64:67], v1, s[12:15], s44 offen offset:0 sc1 nt
  buffer_load_dwordx4 v[68:71], v1, s[12:15], s44 offen offset:1024 sc1 nt
  buffer_load_dwordx4 v[72:75], v1, s[12:15], s44 offen offset:2048 sc1 nt
  buffer_load_dwordx4 v[76:79], v1, s[12:15], s44 offen offset:3072 sc1 nt
  buffer_load_dwordx4 v[80:83], v1, s[12:15], s45 offen offset:0 sc1 nt
  buffer_load_dwordx4 v[84:87], v1, s[12:15], s45 offen offset:1024 sc1 nt
  buffer_load_dwordx4 v[88:91], v1, s[12:15], s45 offen offset:2048 sc1 nt
  buffer_load_dwordx4 v[92:95], v1, s[12:15], s45 offen offset:3072 sc1 nt
  s_waitcnt vmcnt(0)
  v_xor_b32 v61, v64, v42
  v_bitop3_b32 v61, v61, v65, v42 bitop3:0xf6
  v_bitop3_b32 v61, v61, v66, v42 bitop3:0xf6
  v_bitop3_b32 v61, v61, v67, v42 bitop3:0xf6
  v_bitop3_b32 v61, v61, v68, v42 bitop3:0xf6
  v_bitop3_b32 v61, v61, v69, v42 bitop3:0xf6
  v_bitop3_b32 v61, v61, v70, v42 bitop3:0xf6
  v_bitop3_b32 v61, v61, v71, v42 bitop3:0xf6
  v_bitop3_b32 v61, v61, v72, v42 bitop3:0xf6
  v_bitop3_b32 v61, v61, v73, v42 bitop3:0xf6
  v_bitop3_b32 v61, v61, v74, v42 bitop3:0xf6
  v_bitop3_b32 v61, v61, v75, v42 bitop3:0xf6
  v_bitop3_b32 v61, v61, v76, v42 bitop3:0xf6
  v_bitop3_b32 v61, v61, v77, v42 bitop3:0xf6
  v_bitop3_b32 v61, v61, v78, v42 bitop3:0xf6
  v_bitop3_b32 v61, v61, v79, v42 bitop3:0xf6
  v_bitop3_b32 v61, v61, v80, v42 bitop3:0xf6
  v_bitop3_b32 v61, v61, v81, v42 bitop3:0xf6
  v_bitop3_b32 v61, v61, v82, v42 bitop3:0xf6
  v_bitop3_b32 v61, v61, v83, v42 bitop3:0xf6
  v_bitop3_b32 v61, v61, v84, v42 bitop3:0xf6
  v_bitop3_b32 v61, v61, v85, v42 bitop3:0xf6
  v_bitop3_b32 v61, v61, v86, v42 bitop3:0xf6
  v_bitop3_b32 v61, v61, v87, v42 bitop3:0xf6
  v_bitop3_b32 v61, v61, v88, v42 bitop3:0xf6
  v_bitop3_b32 v61, v61, v89, v42 bitop3:0xf6
  v_bitop3_b32 v61, v61, v90, v42 bitop3:0xf6
  v_bitop3_b32 v61, v61, v91, v42 bitop3:0xf6
  v_bitop3_b32 v61, v61, v92, v42 bitop3:0xf6
  v_bitop3_b32 v61, v61, v93, v42 bitop3:0xf6
  v_bitop3_b32 v61, v61, v94, v42 bitop3:0xf6
  v_bitop3_b32 v61, v61, v95, v42 bitop3:0xf6
  v_and_b32 v60, 0xff, v61
  v_cmp_ne_u32 vcc, 0, v60
  s_cbranch_vccz L_q_ok
  s_sleep 8
  s_add_u32 s57, s57, 1
  s_cmp_lg_u32 s57, 3
  s_cbranch_scc1 L_q_next
  s_mov_b32 exec_hi, 0
  buffer_store_dwordx4 v[12:15], v31, s[12:15], s61 offen sc1
  buffer_store_dwordx4 v[8:11], v31, s[12:15], s62 offen sc1
  s_mov_b64 exec, -1
L_q_next:
  s_cmp_lt_u32 s57, 200000
  s_cbranch_scc1 L_q_poll
L_q_ok:
  v_and_b32 v61, 0xf00, v61
  v_cmp_ne_u32 vcc, 0, v61
  s_mov_b32 s44, 2
  s_cbranch_vccz L_q_near
  s_mov_b32 s44, 1
  s_mov_b32 exec_hi, 0
  buffer_store_dwordx4 v[12:15], v31, s[12:15], s61 offen sc1
  buffer_store_dwordx4 v[8:11], v31, s[12:15], s62 offen sc1
  s_mov_b64 exec, -1
L_q_near:
  v_and_b32 v64, s28, v64
  v_and_b32 v65, s28, v65
  v_and_b32 v66, s28, v66
  v_and_b32 v67, s28, v67
  v_and_b32 v68, s28, v68
  v_and_b32 v69, s28, v69
  v_and_b32 v70, s28, v70
  v_and_b32 v71, s28, v71
  v_and_b32 v72, s28, v72
  v_and_b32 v73, s28, v73
  v_and_b32 v74, s28, v74
  v_and_b32 v75, s28, v75
  v_and_b32 v76, s28, v76
  v_and_b32 v77, s28, v77
  v_and_b32 v78, s28, v78
  v_and_b32 v79, s28, v79
  v_and_b32 v80, s28, v80
  v_and_b32 v81, s28, v81
  v_and_b32 v82, s28, v82
  v_and_b32 v83, s28, v83
  v_and_b32 v84, s28, v84
  v_and_b32 v85, s28, v85
  v_and_b32 v86, s28, v86
  v_and_b32 v87, s28, v87
  v_and_b32 v88, s28, v88
  v_and_b32 v89, s28, v89
  v_and_b32 v90, s28, v90
  v_and_b32 v91, s28, v91
  v_and_b32 v92, s28, v92
  v_and_b32 v93, s28, v93
  v_and_b32 v94, s28, v94
  v_and_b32 v95, s28, v95
  v_add_f32 v64, v64, v68
  v_add_f32 v65, v65, v69
  v_add_f32 v66, v66, v70
  v_add_f32 v67, v67, v71
  v_add_f32 v64, v64, v72
  v_add_f32 v65, v65, v73
  v_add_f32 v66, v66, v74
  v_add_f32 v67, v67, v75
  v_add_f32 v64, v64, v76
  v_add_f32 v65, v65, v77
  v_add_f32 v66, v66, v78
  v_add_f32 v67, v67, v79
  v_add_f32 v64, v64, v80
  v_add_f32 v65, v65, v81
  v_add_f32 v66, v66, v82
  v_add_f32 v67, v67, v83
  v_add_f32 v64, v64, v84
  v_add_f32 v65, v65, v85
  v_add_f32 v66, v66, v86
  v_add_f32 v67, v67, v87
  v_add_f32 v64, v64, v88
  v_add_f32 v65, v65, v89
  v_add_f32 v66, v66, v90
  v_add_f32 v67, v67, v91
  v_add_f32 v64, v64, v92
  v_add_f32 v65, v65, v93
  v_add_f32 v66, v66, v94
  v_add_f32 v67, v67, v95
  v_mov_b32 v68, v64
  v_mov_b32 v69, v65
  v_mov_b32 v70, v66
  v_mov_b32 v71, v67
  s_nop 1
  v_permlane32_swap_b32 v64, v68
  v_permlane32_swap_b32 v65, v69
  v_permlane32_swap_b32 v66, v70
  v_permlane32_swap_b32 v67, v71
  s_nop 1
  v_add_f32 v64, v64, v68
  v_add_f32 v65, v65, v69
  v_add_f32 v66, v66, v70
  v_add_f32 v67, v67, v71
  v_cvt_pk_bf16_f32 v64, v64, v65
  v_cvt_pk_bf16_f32 v65, v66, v67
  v_lshlrev_b32 v60, 3, v0
  v_mov_b32 v61, s44
  s_mov_b32 exec_hi, 0
  ds_write_b64 v60, v[64:65] offset:0
  s_waitcnt lgkmcnt(0)
  ds_write_b32 v57, v61 offset:384
  s_mov_b64 exec, -1
  s_lshl3_add_u32 s30, s24, s25
  s_lshl_b32 s30, s30, 4
  s_add_u32 s30, s30, 32768
  v_and_b32 v2, 3, v0
  v_lshlrev_b32 v2, 3, v2
  s_mov_b32 s63, 0
L_s4_wait:
  s_sleep 2
  ds_read_b32 v60, v57 offset:404
  s_add_u32 s63, s63, 1
  s_waitcnt lgkmcnt(0)
  v_readfirstlane_b32 s31, v60
  s_cmp_gt_u32 s63, 1600000
  s_cbranch_scc1 L_s4_wait_x
  s_cmp_lt_u32 s31, 4
  s_cbranch_scc1 L_s4_wait
L_s4_wait_x:
  ds_read_b64 v[68:69], v2 offset:448
  s_waitcnt vmcnt(0) lgkmcnt(0)
  v_max_f32_dpp v64, v68, v68 quad_perm:[1,0,3,2] row_mask:0xf bank_mask:0xf
  s_nop 1
  v_max_f32_dpp v64, v64, v64 quad_perm:[2,3,0,1] row_mask:0xf bank_mask:0xf
  v_sub_f32 v68, v68, v64
  v_mul_f32 v68, 0x3fb8aa3b, v68
  v_exp_f32 v68, v68
  s_nop 0
  ds_write_b32 v2, v68 offset:256
  v_mul_f32 v65, v68, v69
  s_waitcnt lgkmcnt(0)
  ds_write_b32 v57, v53 offset:420
  v_add_f32_dpp v65, v65, v65 quad_perm:[1,0,3,2] row_mask:0xf bank_mask:0xf
  s_nop 1
  v_add_f32_dpp v65, v65, v65 quad_perm:[2,3,0,1] row_mask:0xf bank_mask:0xf
  v_or_b32 v64, v64, v7
  v_and_or_b32 v65, v65, s28, v7
  v_mov_b32 v66, v7
  v_mov_b32 v67, v7
  s_mov_b64 exec, 1
  s_cmp_lg_u32 s44, 2
  s_cbranch_scc1 L_far_2
  buffer_store_dwordx4 v[64:67], off, s[12:15], s30
L_far_2_d:
  s_mov_b64 exec, -1
  s_branch L_tail
L_other2:
  s_waitcnt lgkmcnt(0)
  s_setprio 2
  s_load_dword s26, s[54:55], 0
  s_mov_b64 s[12:13], s[54:55]
  s_mov_b32 s14, 2097152
  s_mov_b32 s15, 0x20000
  s_mov_b64 s[16:17], s[40:41]
  s_mov_b32 s18, 0x400000
  s_mov_b32 s19, 0x20000
  s_mov_b32 s28, 0xfffff000
  v_lshlrev_b32 v31, 5, v29
  v_lshl_or_b32 v31, v28, 4, v31
  v_mov_b32 v57, 0
  v_bfe_u32 v60, v0, 1, 2
  v_and_b32 v61, 1, v0
  v_lshlrev_b32 v61, 4, v61
  v_mov_b32 v62, 0xffff
  v_lshlrev_b32 v62, v61, v62
  v_cmp_eq_u32 vcc, 0, v60
  s_nop 1
  v_cndmask_b32 v3, 0, v62, vcc
  v_cmp_eq_u32 vcc, 1, v60
  s_nop 1
  v_cndmask_b32 v4, 0, v62, vcc
  v_cmp_eq_u32 vcc, 2, v60
  s_nop 1
  v_cndmask_b32 v5, 0, v62, vcc
  v_cmp_eq_u32 vcc, 3, v60
  s_nop 1
  v_cndmask_b32 v6, 0, v62, vcc
  s_waitcnt lgkmcnt(0)
  s_add_u32 s27, s26, 1
  s_and_b32 s27, s27, 4095
  v_mov_b32 v7, s27
  v_mov_b32 v53, 16
  s_mov_b64 exec, 1
  ds_add_u32 v57, v53 offset:388
  s_mov_b64 exec, -1
  s_cmp_eq_u32 s3, 6
  s_cbranch_scc1 L_tail
  s_cmp_ge_u32 s60, 22
  s_cbranch_scc1 L_tail
  s_mul_i32 s56, s59, 22
  s_add_u32 s56, s56, s60
  s_cmp_ge_u32 s56, 172
  s_cbranch_scc1 L_tail
  s_mov_b64 s[4:5], s[48:49]
  s_mov_b32 s6, 1409024
  v_lshl_or_b32 v2, v28, 11, v30
  s_lshl_b32 s29, s56, 13
  buffer_load_dwordx4 v[128:131], v2, s[4:7], s29 offen offset:0 nt
  buffer_load_dwordx4 v[132:135], v2, s[4:7], s29 offen offset:256 nt
  buffer_load_dwordx4 v[136:139], v2, s[4:7], s29 offen offset:512 nt
  buffer_load_dwordx4 v[140:143], v2, s[4:7], s29 offen offset:768 nt
  buffer_load_dwordx4 v[144:147], v2, s[4:7], s29 offen offset:1024 nt
  buffer_load_dwordx4 v[148:151], v2, s[4:7], s29 offen offset:1280 nt
  buffer_load_dwordx4 v[152:155], v2, s[4:7], s29 offen offset:1536 nt
  buffer_load_dwordx4 v[156:159], v2, s[4:7], s29 offen offset:1792 nt
  v_lshlrev_b32 v2, 9, v29
  v_lshl_or_b32 v2, v28, 3, v2
  s_cmp_ge_u32 s60, 11
  s_cselect_b32 s30, 16*512-11*32, 0
  s_lshl_b32 s29, s60, 5
  s_add_u32 s30, s30, s29
  s_lshl_b32 s29, s59, 14
  s_add_u32 s30, s30, s29
  s_add_u32 s30, s30, 327680
  s_mov_b32 s57, 0
  s_mov_b32 s63, 0
L_f_wait:
  s_sleep 4
  ds_read_b32 v60, v57 offset:396
  s_add_u32 s63, s63, 1
  s_waitcnt lgkmcnt(0)
  v_readfirstlane_b32 s31, v60
  s_cmp_gt_u32 s63, 1600000
  s_cbranch_scc1 L_f_wait_x
  s_cmp_lt_u32 s31, 2
  s_cbranch_scc1 L_f_wait
L_f_wait_x:
L_f_poll:
  buffer_load_dwordx2 v[64:65], v2, s[12:15], s30 offen sc1 nt
  s_waitcnt vmcnt(0)
  v_xor_b32 v64, v64, v7
  v_xor_b32 v65, v65, v7
  v_or_b32 v60, v64, v65
  v_and_b32 v60, 4095, v60
  v_cmp_ne_u32 vcc, 0, v60
  s_cbranch_vccz L_f_ok
  s_sleep 16
  s_add_u32 s57, s57, 1
  s_cmp_lt_u32 s57, 200000
  s_cbranch_scc1 L_f_poll
L_f_ok:
  s_nop 0
  v_add_f32_dpp v64, v64, v64 quad_perm:[1,0,3,2] row_mask:0xf bank_mask:0xf
  v_add_f32_dpp v65, v65, v65 quad_perm:[1,0,3,2] row_mask:0xf bank_mask:0xf
  s_nop 0
  v_add_f32_dpp v64, v64, v64 quad_perm:[2,3,0,1] row_mask:0xf bank_mask:0xf
  v_add_f32_dpp v65, v65, v65 quad_perm:[2,3,0,1] row_mask:0xf bank_mask:0xf
  s_nop 0
  v_add_f32_dpp v64, v64, v64 row_half_mirror row_mask:0xf bank_mask:0xf
  v_add_f32_dpp v65, v65, v65 row_half_mirror row_mask:0xf bank_mask:0xf
  v_cvt_pk_bf16_f32 v64, v64, v64
  v_and_b32 v64, 0xffff0000, v64
  v_cvt_pk_bf16_f32 v65, v65, v65
  v_and_b32 v65, 0xffff0000, v65
  s_nop 1
  v_mov_b32_dpp v66, v64 row_ror:8 row_mask:0xf bank_mask:0xf
  v_mov_b32_dpp v67, v65 row_ror:8 row_mask:0xf bank_mask:0xf
  s_mov_b32 s57, 0xbdd2d3e8
  v_mov_b32 v26, 0xc0135761
  v_mul_f32 v24, v64, v64
  v_fma_f32 v24, v24, s57, v26
  v_mul_f32 v24, v24, v64
  v_exp_f32 v24, v24
  s_nop 0
  v_add_f32 v24, 1.0, v24
  v_rcp_f32 v24, v24
  s_nop 0
  v_mul_f32 v64, v64, v24
  v_cvt_pk_bf16_f32 v64, v64, v64
  v_and_b32 v64, 0xffff0000, v64
  v_mul_f32 v64, v64, v66
  v_cvt_pk_bf16_f32 v64, v64, v64
  v_and_b32 v72, v64, v3
  v_and_b32 v73, v64, v4
  v_and_b32 v74, v64, v5
  v_and_b32 v75, v64, v6
  v_mul_f32 v24, v65, v65
  v_fma_f32 v24, v24, s57, v26
  v_mul_f32 v24, v24, v65
  v_exp_f32 v24, v24
  s_nop 0
  v_add_f32 v24, 1.0, v24
  v_rcp_f32 v24, v24
  s_nop 0
  v_mul_f32 v65, v65, v24
  v_cvt_pk_bf16_f32 v65, v65, v65
  v_and_b32 v65, 0xffff0000, v65
  v_mul_f32 v65, v65, v67
  v_cvt_pk_bf16_f32 v65, v65, v65
  v_and_b32 v76, v65, v3
  v_and_b32 v77, v65, v4
  v_and_b32 v78, v65, v5
  v_and_b32 v79, v65, v6
  s_nop 1
  v_mfma_f32_16x16x32_bf16 v[36:39], v[72:75], v[128:131], 0
  v_mfma_f32_16x16x32_bf16 v[36:39], v[76:79], v[144:147], v[36:39]
  v_mfma_f32_16x16x32_bf16 v[40:43], v[72:75], v[132:135], 0
  v_mfma_f32_16x16x32_bf16 v[40:43], v[76:79], v[148:151], v[40:43]
  v_mfma_f32_16x16x32_bf16 v[44:47], v[72:75], v[136:139], 0
  v_mfma_f32_16x16x32_bf16 v[44:47], v[76:79], v[152:155], v[44:47]
  v_mfma_f32_16x16x32_bf16 v[48:51], v[72:75], v[140:143], 0
  v_mfma_f32_16x16x32_bf16 v[48:51], v[76:79], v[156:159], v[48:51]
  s_mul_i32 s29, s56, 2176
  s_add_u32 s29, s29, 1310720
  s_mov_b32 s63, 0
L_m_wait:
  s_sleep 4
  ds_read_b32 v60, v57 offset:392
  s_add_u32 s63, s63, 1
  s_waitcnt lgkmcnt(0)
  v_readfirstlane_b32 s31, v60
  s_cmp_gt_u32 s63, 1600000
  s_cbranch_scc1 L_m_wait_x
  s_cmp_lt_u32 s31, 1
  s_cbranch_scc1 L_m_wait
L_m_wait_x:
  s_nop 7
  v_and_or_b32 v36, v36, s28, v7
  v_and_or_b32 v37, v37, s28, v7
  v_and_or_b32 v38, v38, s28, v7
  v_and_or_b32 v39, v39, s28, v7
  v_and_or_b32 v40, v40, s28, v7
  v_and_or_b32 v41, v41, s28, v7
  v_and_or_b32 v42, v42, s28, v7
  v_and_or_b32 v43, v43, s28, v7
  v_and_or_b32 v44, v44, s28, v7
  v_and_or_b32 v45, v45, s28, v7
  v_and_or_b32 v46, v46, s28, v7
  v_and_or_b32 v47, v47, s28, v7
  v_and_or_b32 v48, v48, s28, v7
  v_and_or_b32 v49, v49, s28, v7
  v_and_or_b32 v50, v50, s28, v7
  v_and_or_b32 v51, v51, s28, v7
  s_mov_b32 exec_hi, 0
  s_cmp_lg_u32 s31, 2
  s_cbranch_scc1 L_far_3
  buffer_store_dwordx4 v[36:39], v31, s[12:15], s29 offen offset:0
  buffer_store_dwordx4 v[40:43], v31, s[12:15], s29 offen offset:512
  buffer_store_dwordx4 v[44:47], v31, s[12:15], s29 offen offset:1024
  buffer_store_dwordx4 v[48:51], v31, s[12:15], s29 offen offset:1536
L_far_3_d:
  s_mov_b64 exec, -1
L_tail:
  s_sub_u32 s58, s3, 4
  v_and_b32 v33, 7, v0
  v_lshlrev_b32 v33, 4, v33
  v_lshrrev_b32 v34, 3, v0
  v_and_b32 v35, 1, v34
  v_lshl_or_b32 v2, v28, 10, v33
  v_lshl_or_b32 v2, v35, 14, v2
  s_lshl2_add_u32 s29, s24, s58
  s_lshl_b32 s20, s29, 15
  s_lshl_b32 s31, s25, 7
  s_add_u32 s20, s20, s31
  s_add_u32 s21, s20, 0x1000
  s_add_u32 s22, s21, 0x1000
  s_add_u32 s23, s22, 0x1000
  v_mul_u32_u24 v32, 640, v34
  v_add_u32 v32, v32, v33
  s_mul_i32 s36, s24, 5120
  s_lshl_b32 s31, s58, 7
  s_add_u32 s36, s36, s31
  s_add_u32 s36, s36, 524288
  s_lshl3_add_u32 s62, s24, s25
  s_lshl_b32 s62, s62, 8
  s_add_u32 s62, s62, 458752
  v_lshlrev_b32 v37, 1, v33
  v_and_b32 v38, 1, v28
  v_lshl_or_b32 v37, v38, 4, v37
  v_lshl_or_b32 v37, v35, 9, v37
  s_lshl_b32 s31, s58, 10
  v_add_u32 v37, s31, v37
  v_mov_b32 v39, 1
  v_lshlrev_b32 v36, 4, v34
  s_mul_i32 s44, s59, 47872
  s_lshl_b32 s31, s60, 6
  s_add_u32 s44, s44, s31
  s_add_u32 s44, s44, 1310720
  s_add_u32 s45, s44, 34816
  v_lshrrev_b32 v58, 2, v0
  v_mul_u32_u24 v58, 2176, v58
  v_and_b32 v38, 3, v0
  v_lshl_add_u32 v58, v38, 4, v58
  s_movk_i32 s46, 0xff
  s_cmp_eq_u32 s59, 7
  s_cselect_b32 s46, s46, 0xffffff
  s_mov_b32 s47, 0
  v_mov_b32 v104, v7
  v_mov_b32 v105, v7
  v_mov_b32 v106, v7
  v_mov_b32 v107, v7
  v_lshlrev_b32 v40, 3, v0
  v_lshlrev_b32 v43, 2, v0
  s_lshl_b32 s43, s60, 10
  s_lshl_b32 s31, s59, 7
  s_add_u32 s43, s43, s31
  s_add_u32 s43, s43, 1703680
  v_mov_b32 v41, s62
  v_mov_b32 v42, s43
  v_cmp_gt_u32 vcc, 32, v0
  s_nop 1
  v_cndmask_b32 v41, v42, v41, vcc
  v_add_u32 v41, v41, v40
  s_lshl_b32 s61, s24, 7
  s_add_u32 s61, s61, 32768
  s_mov_b32 s57, 0
  s_cmp_lg_u32 s3, 6
  s_cbranch_scc1 L_y_done
  s_mov_b32 s63, 0
L_y_wait:
  s_sleep 4
  ds_read_b32 v60, v57 offset:436
  s_add_u32 s63, s63, 1
  s_waitcnt lgkmcnt(0)
  v_readfirstlane_b32 s31, v60
  s_cmp_gt_u32 s63, 1600000
  s_cbranch_scc1 L_y_wait_x
  s_cmp_lt_u32 s31, 2
  s_cbranch_scc1 L_y_wait
L_y_wait_x:
L_y_poll:
  v_mov_b32 v104, v7
  v_mov_b32 v105, v7
  v_mov_b32 v106, v7
  v_mov_b32 v107, v7
  buffer_load_dwordx4 v[100:103], v58, s[12:15], s44 offen sc1 nt
  s_mov_b64 exec, s[46:47]
  buffer_load_dwordx4 v[104:107], v58, s[12:15], s45 offen sc1 nt
  s_mov_b64 exec, -1
  s_waitcnt vmcnt(0)
  v_xor_b32 v100, v100, v7
  v_xor_b32 v101, v101, v7
  v_xor_b32 v102, v102, v7
  v_xor_b32 v103, v103, v7
  v_xor_b32 v104, v104, v7
  v_xor_b32 v105, v105, v7
  v_xor_b32 v106, v106, v7
  v_xor_b32 v107, v107, v7
  v_or3_b32 v60, v100, v101, v102
  v_or3_b32 v60, v60, v103, v104
  v_or3_b32 v60, v60, v105, v106
  v_or_b32 v60, v60, v107
  v_and_b32 v60, 4095, v60
  v_cmp_ne_u32 vcc, 0, v60
  s_cbranch_vccz L_y_ok
  s_sleep 8
  s_add_u32 s57, s57, 1
  s_cmp_lt_u32 s57, 200000
  s_cbranch_scc1 L_y_poll
L_y_ok:
  v_add_f32 v100, v100, v104
  v_add_f32 v101, v101, v105
  v_add_f32 v102, v102, v106
  v_add_f32 v103, v103, v107
  v_add_f32_dpp v100, v100, v100 row_ror:4 row_mask:0xf bank_mask:0xf
  v_add_f32_dpp v101, v101, v101 row_ror:4 row_mask:0xf bank_mask:0xf
  v_add_f32_dpp v102, v102, v102 row_ror:4 row_mask:0xf bank_mask:0xf
  v_add_f32_dpp v103, v103, v103 row_ror:4 row_mask:0xf bank_mask:0xf
  v_add_f32_dpp v100, v100, v100 row_ror:8 row_mask:0xf bank_mask:0xf
  v_add_f32_dpp v101, v101, v101 row_ror:8 row_mask:0xf bank_mask:0xf
  v_add_f32_dpp v102, v102, v102 row_ror:8 row_mask:0xf bank_mask:0xf
  v_add_f32_dpp v103, v103, v103 row_ror:8 row_mask:0xf bank_mask:0xf
  v_mov_b32 v104, v100
  v_mov_b32 v105, v101
  v_mov_b32 v106, v102
  v_mov_b32 v107, v103
  s_nop 1
  v_permlane32_swap_b32 v100, v104
  v_permlane32_swap_b32 v101, v105
  v_permlane32_swap_b32 v102, v106
  v_permlane32_swap_b32 v103, v107
  v_add_f32 v100, v100, v104
  v_add_f32 v101, v101, v105
  v_add_f32 v102, v102, v106
  v_add_f32 v103, v103, v107
  v_mov_b32 v104, v100
  v_mov_b32 v105, v101
  v_mov_b32 v106, v102
  v_mov_b32 v107, v103
  s_nop 1
  v_permlane16_swap_b32 v100, v104
  v_permlane16_swap_b32 v101, v105
  v_permlane16_swap_b32 v102, v106
  v_permlane16_swap_b32 v103, v107
  v_add_f32 v100, v100, v104
  v_add_f32 v101, v101, v105
  v_add_f32 v102, v102, v106
  v_add_f32 v103, v103, v107
  v_and_or_b32 v100, v100, s28, v7
  v_and_or_b32 v101, v101, s28, v7
  v_and_or_b32 v102, v102, s28, v7
  v_and_or_b32 v103, v103, s28, v7
  s_mov_b64 exec, 0xff
  buffer_store_dwordx4 v[100:103], v30, s[12:15], s43 offen offset:256 sc1
  s_mov_b64 exec, -1
  s_mov_b32 s57, 0
L_y_done:
  s_mov_b32 s63, 0
L_wait_s:
  s_sleep 2
  ds_read_b32 v60, v57 offset:388
  s_add_u32 s63, s63, 1
  s_waitcnt lgkmcnt(0)
  v_readfirstlane_b32 s31, v60
  s_cmp_gt_u32 s63, 1600000
  s_cbranch_scc1 L_wait_s_x
  s_cmp_lt_u32 s31, 66
  s_cbranch_scc1 L_wait_s
L_wait_s_x:
  buffer_load_dwordx4 v[68:71], v32, s[12:15], s36 offen sc1 nt
  buffer_load_dwordx4 v[64:67], v36, s[12:15], s61 offen sc1 nt
  s_mov_b32 s63, 0
L_wait_v:
  s_sleep 1
  ds_read_b32 v60, v57 offset:388
  s_add_u32 s63, s63, 1
  s_waitcnt lgkmcnt(0)
  v_readfirstlane_b32 s31, v60
  s_cmp_gt_u32 s63, 1600000
  s_cbranch_scc1 L_wait_v_x
  s_cmp_lt_u32 s31, 68
  s_cbranch_scc1 L_wait_v
L_wait_v_x:
  buffer_load_dwordx4 v[112:115], v2, s[16:19], s20 offen nt
  buffer_load_dwordx4 v[116:119], v2, s[16:19], s21 offen nt
  buffer_load_dwordx4 v[120:123], v2, s[16:19], s22 offen nt
  buffer_load_dwordx4 v[124:127], v2, s[16:19], s23 offen nt
  s_waitcnt vmcnt(4)
  s_branch L_s_chk
L_s_poll:
  buffer_load_dwordx4 v[64:67], v36, s[12:15], s61 offen sc1 nt
  s_waitcnt vmcnt(0)
L_s_chk:
  v_xor_b32 v64, v64, v7
  v_xor_b32 v65, v65, v7
  v_xor_b32 v66, v66, v7
  v_xor_b32 v67, v67, v7
  v_or3_b32 v60, v64, v65, v66
  v_or_b32 v60, v60, v67
  v_and_b32 v60, 4095, v60
  v_cmp_ne_u32 vcc, 0, v60
  s_cbranch_vccz L_s_ok
  s_sleep 2
  s_add_u32 s57, s57, 1
  s_cmp_lt_u32 s57, 200000
  s_cbranch_scc1 L_s_poll
L_s_ok:
  v_mov_b32 v60, v64
  s_nop 1
  v_max_f32_dpp v60, v60, v60 row_ror:8 row_mask:0xf bank_mask:0xf
  s_nop 1
  v_max_f32_dpp v60, v60, v60 row_bcast:15 row_mask:0xa bank_mask:0xf
  s_nop 1
  v_max_f32_dpp v60, v60, v60 row_bcast:31 row_mask:0xc bank_mask:0xf
  s_nop 0
  v_readlane_b32 s31, v60, 63
  s_nop 1
  v_subrev_f32 v88, s31, v64
  v_mul_f32 v88, 0x3fb8aa3b, v88
  v_exp_f32 v88, v88
  s_nop 0
  v_mul_f32 v60, v88, v65
  s_nop 1
  v_add_f32_dpp v60, v60, v60 row_ror:8 row_mask:0xf bank_mask:0xf
  s_nop 1
  v_add_f32_dpp v60, v60, v60 row_bcast:15 row_mask:0xa bank_mask:0xf
  s_nop 1
  v_add_f32_dpp v60, v60, v60 row_bcast:31 row_mask:0xc bank_mask:0xf
  s_nop 0
  v_readlane_b32 s31, v60, 63
  s_nop 1
  v_rcp_f32 v60, s31
  s_mov_b32 s57, 0
  v_mul_f32 v88, v88, v60
  s_mov_b32 s63, 0
L_wait_h:
  ds_read_b32 v60, v57 offset:432
  s_add_u32 s63, s63, 1
  s_waitcnt lgkmcnt(0)
  v_readfirstlane_b32 s31, v60
  s_cmp_gt_u32 s63, 1600000
  s_cbranch_scc1 L_wait_h_x
  s_cmp_lt_u32 s31, 1
  s_cbranch_scc1 L_wait_h
L_wait_h_x:
  buffer_load_dwordx4 v[64:67], v32, s[12:15], s36 offen sc1 nt
L_h1_poll:
  buffer_load_dwordx4 v[68:71], v32, s[12:15], s36 offen sc1 nt
  s_waitcnt vmcnt(1)
  v_xor_b32 v64, v64, v7
  v_xor_b32 v65, v65, v7
  v_xor_b32 v66, v66, v7
  v_xor_b32 v67, v67, v7
  v_or3_b32 v60, v64, v65, v66
  v_or_b32 v60, v60, v67
  v_and_b32 v60, 4095, v60
  v_cmp_ne_u32 vcc, 0, v60
  s_cbranch_vccz L_h1_ok
  buffer_load_dwordx4 v[64:67], v32, s[12:15], s36 offen sc1 nt
  s_waitcnt vmcnt(1)
  v_xor_b32 v68, v68, v7
  v_xor_b32 v69, v69, v7
  v_xor_b32 v70, v70, v7
  v_xor_b32 v71, v71, v7
  v_or3_b32 v60, v68, v69, v70
  v_or_b32 v60, v60, v71
  v_and_b32 v60, 4095, v60
  v_cmp_ne_u32 vcc, 0, v60
  s_cbranch_vccz L_h1_ok2
  s_add_u32 s57, s57, 1
  s_cmp_lt_u32 s57, 200000
  s_cbranch_scc1 L_h1_poll
L_h1_ok2:
  v_mul_f32 v96, v68, v88
  v_mul_f32 v98, v70, v88
  v_mul_f32 v97, v69, v88
  v_mul_f32 v99, v71, v88
  s_branch L_h1_join
L_h1_ok:
  v_mul_f32 v96, v64, v88
  v_mul_f32 v98, v66, v88
  v_mul_f32 v97, v65, v88
  v_mul_f32 v99, v67, v88
  s_nop 0
L_h1_join:
  v_permlane32_swap_b32 v96, v98
  v_permlane32_swap_b32 v97, v99
  v_add_f32 v96, v96, v98
  v_add_f32 v97, v97, v99
  s_nop 1
  v_permlane16_swap_b32 v96, v97
  v_add_f32 v96, v96, v97
  s_nop 1
  v_add_f32_dpp v96, v96, v96 row_ror:8 row_mask:0xf bank_mask:0xf
  v_cvt_pk_bf16_f32 v96, v96, v96
  s_nop 1
  v_mov_b32_dpp v96, v96 row_ror:4 row_mask:0xf bank_mask:0x6
  s_nop 1
  v_and_b32_dpp v72, v96, v3 quad_perm:[0,0,0,0] row_mask:0xf bank_mask:0xf
  v_and_b32_dpp v73, v96, v4 quad_perm:[0,0,0,0] row_mask:0xf bank_mask:0xf
  v_and_b32_dpp v74, v96, v5 quad_perm:[0,0,0,0] row_mask:0xf bank_mask:0xf
  v_and_b32_dpp v75, v96, v6 quad_perm:[0,0,0,0] row_mask:0xf bank_mask:0xf
  v_and_b32_dpp v76, v96, v3 quad_perm:[1,1,1,1] row_mask:0xf bank_mask:0xf
  v_and_b32_dpp v77, v96, v4 quad_perm:[1,1,1,1] row_mask:0xf bank_mask:0xf
  v_and_b32_dpp v78, v96, v5 quad_perm:[1,1,1,1] row_mask:0xf bank_mask:0xf
  v_and_b32_dpp v79, v96, v6 quad_perm:[1,1,1,1] row_mask:0xf bank_mask:0xf
  v_mfma_f32_16x16x32_bf16 v[8:11], v[72:75], v[112:115], 0
  v_and_b32_dpp v80, v96, v3 quad_perm:[2,2,2,2] row_mask:0xf bank_mask:0xf
  v_and_b32_dpp v81, v96, v4 quad_perm:[2,2,2,2] row_mask:0xf bank_mask:0xf
  v_and_b32_dpp v82, v96, v5 quad_perm:[2,2,2,2] row_mask:0xf bank_mask:0xf
  v_and_b32_dpp v83, v96, v6 quad_perm:[2,2,2,2] row_mask:0xf bank_mask:0xf
  v_mfma_f32_16x16x32_bf16 v[8:11], v[76:79], v[116:119], v[8:11]
  v_and_b32_dpp v84, v96, v3 quad_perm:[3,3,3,3] row_mask:0xf bank_mask:0xf
  v_and_b32_dpp v85, v96, v4 quad_perm:[3,3,3,3] row_mask:0xf bank_mask:0xf
  v_and_b32_dpp v86, v96, v5 quad_perm:[3,3,3,3] row_mask:0xf bank_mask:0xf
  v_and_b32_dpp v87, v96, v6 quad_perm:[3,3,3,3] row_mask:0xf bank_mask:0xf
  v_mfma_f32_16x16x32_bf16 v[8:11], v[80:83], v[120:123], v[8:11]
  s_nop 0
  v_mfma_f32_16x16x32_bf16 v[8:11], v[84:87], v[124:127], v[8:11]
  s_mov_b32 exec_lo, 0x00ff00ff
  s_mov_b32 exec_hi, 0xff00ff00
  s_nop 5
  ds_write_b128 v37, v[8:11] offset:512
  s_mov_b64 exec, 1
  ds_add_rtn_u32 v60, v57, v39 offset:412
  s_mov_b64 exec, -1
  ds_read2st64_b32 v[128:129], v43 offset0:2 offset1:4
  ds_read2st64_b32 v[130:131], v43 offset0:6 offset1:8
  ds_read2st64_b32 v[132:133], v43 offset0:10 offset1:12
  ds_read2st64_b32 v[134:135], v43 offset0:14 offset1:16
  s_waitcnt lgkmcnt(4)
  v_readfirstlane_b32 s31, v60
  s_cmp_lt_u32 s31, 3
  s_cbranch_scc1 L_exit2
  s_waitcnt lgkmcnt(2)
  v_pk_add_f32 v[128:129], v[128:129], v[130:131]
  s_waitcnt lgkmcnt(0)
  v_pk_add_f32 v[132:133], v[132:133], v[134:135]
  v_add_f32 v128, v128, v129
  v_add_f32 v132, v132, v133
  v_add_f32 v128, v128, v132
  v_and_or_b32 v128, v128, s28, v7
  buffer_store_dword v128, v43, s[12:15], s62 offen sc1
  ds_write_b32 v57, v53 offset:408
L_exit2:
  s_endpgm
L_far_1:
  buffer_store_dwordx4 v[64:67], v58, s[12:15], s37 offen sc1
  s_branch L_far_1_d
L_far_2:
  buffer_store_dwordx4 v[64:67], off, s[12:15], s30 sc1
  s_branch L_far_2_d
L_far_3:
  buffer_store_dwordx4 v[36:39], v31, s[12:15], s29 offen offset:0 sc1
  buffer_store_dwordx4 v[40:43], v31, s[12:15], s29 offen offset:512 sc1
  buffer_store_dwordx4 v[44:47], v31, s[12:15], s29 offen offset:1024 sc1
  buffer_store_dwordx4 v[48:51], v31, s[12:15], s29 offen offset:1536 sc1
  s_branch L_far_3_d
L_code_end:
.section .rodata,"a"
.p2align 6
.amdhsa_kernel recurrent_scan__sliding_block_cached__geglu_ffn__decode_kernel
  .amdhsa_next_free_vgpr 256
  .amdhsa_next_free_sgpr 96
  .amdhsa_accum_offset 256
  .amdhsa_group_segment_fixed_size 0
  .amdhsa_kernarg_size 96
  .amdhsa_user_sgpr_count 2
  .amdhsa_user_sgpr_kernarg_segment_ptr 1
  .amdhsa_system_sgpr_workgroup_id_x 1
.end_amdhsa_kernel
```
